```python
import torch

def _softmax(x, axis=-1):
    return torch.softmax(x, dim=axis)
def _gelu(x):
    return torch.nn.functional.gelu(x, approximate="tanh")
def _silu(x):
    return torch.nn.functional.silu(x)
def _sigmoid(x):
    return torch.sigmoid(x)
def _layernorm(x, axis=-1, eps=1e-5):
    m = x.mean(dim=axis, keepdim=True)
    v = x.var(dim=axis, keepdim=True, unbiased=False)
    return (x - m) / torch.sqrt(v + eps)
def _scatter_add(tgt, idx, src, axis=0):
    return tgt.clone().index_add_(axis, idx, src)
def _segment_sum(src, seg, n):
    out = torch.zeros((n,) + src.shape[1:], dtype=src.dtype)
    return out.index_add_(0, seg, src)
def _pad(x, pw):
    flat = tuple(v for pair in reversed(pw) for v in pair)
    return torch.nn.functional.pad(x, flat)

kernel_name = 'standalone__kv_cache_quant_int4_int2_kv_with_per_channel_or_per_token_scales__sampling'

def setup_inputs():

    _w = (lambda a: (lambda t: t.to(torch.bfloat16) if t.is_floating_point() else t)(torch.as_tensor(a)))
    B = 8
    Sq = 4
    Skv = 2048
    Hq = 32
    Hkv = 16
    Dh = 128
    bits = 8
    G = 128
    if G <= 0 or G >= Skv:
        G = max(1, Skv // 2)
    Skv = (Skv // G) * G
    ngk = Skv // G
    qmax = (1 << bits) - 1
    return {
        "q": _w((lambda *s: torch.randn(*s, dtype=torch.bfloat16) * 0.4)(B, Hq, Sq, Dh)),
        "qk": _w(torch.randint(0, qmax + 1, (B, Hkv, Skv, Dh)).to(torch.int32)),
        "qv": _w(torch.randint(0, qmax + 1, (B, Hkv, Skv, Dh)).to(torch.int32)),
        "k_scales": _w(torch.abs((lambda *s: torch.randn(*s, dtype=torch.bfloat16) * 0.4)(B, Hkv, ngk, Dh)) * 0.05 + 0.02),
        "k_zeros": _w((lambda *s: torch.randn(*s, dtype=torch.bfloat16) * 0.4)(B, Hkv, ngk, Dh) + float(qmax) / 2.0),
        "v_scales": _w(torch.abs((lambda *s: torch.randn(*s, dtype=torch.bfloat16) * 0.05)(B, Hkv, Skv, 1)) * 0.05 + 0.02),
        "v_zeros": _w((lambda *s: torch.randn(*s, dtype=torch.bfloat16) * 0.05)(B, Hkv, Skv, 1) + float(qmax) / 2.0),
    }

def reference(q, qk, qv, k_scales, k_zeros, v_scales, v_zeros):
    B, Hq, Sq, Dh = q.shape
    Hkv, Skv = qk.shape[1], qk.shape[2]
    ngk = k_scales.shape[2]
    G = Skv // ngk
    ks = (lambda x, n, axis: torch.repeat_interleave(x, n, dim=axis))(k_scales, G, axis=2)
    kz = (lambda x, n, axis: torch.repeat_interleave(x, n, dim=axis))(k_zeros, G, axis=2)
    k = ((lambda x, dt: x.to(dt))(qk, q.dtype) - kz) * ks
    v = ((lambda x, dt: x.to(dt))(qv, q.dtype) - v_zeros) * v_scales
    rep = Hq // Hkv
    if rep > 1:
        k = (lambda x, n, axis: torch.repeat_interleave(x, n, dim=axis))(k, rep, axis=1)
        v = (lambda x, n, axis: torch.repeat_interleave(x, n, dim=axis))(v, rep, axis=1)
    scale = float(Dh) ** -0.5
    logits = torch.einsum("bhqd,bhkd->bhqk", q, k) * scale
    p = _softmax(logits, axis=-1)
    o = torch.einsum("bhqk,bhkd->bhqd", p, v)
    return o
```

```asm
; @launch grid=(256,1,1) block=(512,1,1) lds=59968
.amdgcn_target "amdgcn-amd-amdhsa--gfx950"
.text
.globl standalone__kv_cache_quant_int4_int2_kv_with_per_channel_or_per_token_scales__sampling_kernel
.p2align 8
.type standalone__kv_cache_quant_int4_int2_kv_with_per_channel_or_per_token_scales__sampling_kernel,@function
standalone__kv_cache_quant_int4_int2_kv_with_per_channel_or_per_token_scales__sampling_kernel:
  s_load_dwordx16 s[4:19], s[0:1], 0
  s_load_dwordx4 s[20:23], s[0:1], 64
  s_cmp_ge_u32 s2, 256
  s_cbranch_scc1 L_end
  v_lshrrev_b32 v1, 6, v0
  v_and_b32 v0, 63, v0
  v_readfirstlane_b32 s3, v1
  s_lshr_b32 s67, s2, 1
  s_and_b32 s67, s67, 7
  s_lshl_b32 s67, s67, 16
  s_mov_b32 s71, s3
  s_lshr_b32 s46, s2, 6
  s_and_b32 s46, s46, 3
  s_lshl_b32 s46, s46, 1
  s_xor_b32 s2, s2, s46
  v_bfe_u32 v28, v0, 1, 3
  v_lshrrev_b32 v26, 4, v0
  v_lshlrev_b32 v1, 9, v28
  v_lshl_add_u32 v1, v26, 5, v1
  v_and_b32 v28, 1, v0
  v_lshl_add_u32 v1, v28, 4, v1
  v_lshlrev_b32 v29, 4, v0
  s_lshl_b32 s69, s2, 19
  s_lshl_b32 s38, s71, 12
  s_add_u32 s69, s69, s38
  s_mov_b32 s26, 0x8000000
  s_mov_b32 s27, 0x20000
  s_mov_b32 s37, s67
  s_add_u32 s36, s69, s67
  s_and_b32 s46, s3, 1
  s_lshl_b32 s46, s46, 10
  s_lshl_b32 s47, s2, 11
  s_add_u32 s47, s47, s46
  s_lshr_b32 s39, s2, 1
  s_lshl_b32 s39, s39, 11
  s_add_u32 s39, s39, s46
  s_mov_b32 s34, 0x80000
  s_mov_b32 s35, 0x20000
  s_mov_b32 s50, 0x80000
  s_mov_b32 s51, 0x20000
  s_mov_b32 s54, 0x40000
  s_mov_b32 s55, 0x20000
  s_cmp_lt_u32 s3, 2
  s_waitcnt lgkmcnt(0)
  s_cselect_b32 s32, s10, s14
  s_cselect_b32 s33, s11, s15
  s_cselect_b32 s48, s12, s16
  s_cselect_b32 s49, s13, s17
  s_mov_b32 s52, s4
  s_mov_b32 s53, s5
  s_mov_b32 s24, s6
  s_mov_b32 s25, s7
  s_lshl_b32 s68, s2, 8
  s_add_u32 s68, s68, 2097152
  s_cmp_lt_u32 s3, 2
  s_cbranch_scc0 L_noq
  buffer_load_dwordx4 v[104:107], v29, s[52:55], s39 offen nt
  v_mov_b32 v108, s68
  v_mov_b32 v109, 0
  s_mov_b64 exec, 1
  global_store_dword v108, v109, s[22:23] sc0 sc1
  s_mov_b64 exec, -1
L_noq:
  s_cmp_lt_u32 s3, 4
  s_cbranch_scc0 L_nosc
  buffer_load_dwordx4 v[96:99], v29, s[32:35], s47 offen nt
  buffer_load_dwordx4 v[100:103], v29, s[48:51], s47 offen nt
L_nosc:
  buffer_load_dwordx4 v[32:35], v1, s[24:27], s36 offen offset:0 nt
  buffer_load_dwordx4 v[36:39], v1, s[24:27], s36 offen offset:128 nt
  buffer_load_dwordx4 v[40:43], v1, s[24:27], s36 offen offset:256 nt
  buffer_load_dwordx4 v[44:47], v1, s[24:27], s36 offen offset:384 nt
  s_add_u32 s37, s37, 32768
  s_and_b32 s37, s37, 0x7ffff
  s_add_u32 s36, s69, s37
  buffer_load_dwordx4 v[48:51], v1, s[24:27], s36 offen offset:0 nt
  buffer_load_dwordx4 v[52:55], v1, s[24:27], s36 offen offset:128 nt
  buffer_load_dwordx4 v[56:59], v1, s[24:27], s36 offen offset:256 nt
  buffer_load_dwordx4 v[60:63], v1, s[24:27], s36 offen offset:384 nt
  s_add_u32 s37, s37, 32768
  s_and_b32 s37, s37, 0x7ffff
  s_add_u32 s36, s69, s37
  buffer_load_dwordx4 v[64:67], v1, s[24:27], s36 offen offset:0 nt
  buffer_load_dwordx4 v[68:71], v1, s[24:27], s36 offen offset:128 nt
  buffer_load_dwordx4 v[72:75], v1, s[24:27], s36 offen offset:256 nt
  buffer_load_dwordx4 v[76:79], v1, s[24:27], s36 offen offset:384 nt
  s_add_u32 s37, s37, 32768
  s_and_b32 s37, s37, 0x7ffff
  s_add_u32 s36, s69, s37
  buffer_load_dwordx4 v[80:83], v1, s[24:27], s36 offen offset:0 nt
  buffer_load_dwordx4 v[84:87], v1, s[24:27], s36 offen offset:128 nt
  buffer_load_dwordx4 v[88:91], v1, s[24:27], s36 offen offset:256 nt
  buffer_load_dwordx4 v[92:95], v1, s[24:27], s36 offen offset:384 nt
  s_add_u32 s37, s37, 32768
  s_and_b32 s37, s37, 0x7ffff
  s_add_u32 s36, s69, s37
  s_mov_b32 s28, s8
  s_mov_b32 s29, s9
  s_mov_b32 s30, 0x8000000
  s_mov_b32 s31, 0x20000
  v_and_b32 v27, 15, v0
  v_lshl_add_u32 v3, v26, 1, v28
  v_lshlrev_b32 v3, 5, v3
  v_lshlrev_b32 v2, 10, v26
  v_lshl_add_u32 v2, v27, 4, v2
  s_lshl_b32 s38, s71, 6
  v_lshlrev_b32 v4, 4, v26
  v_add_u32 v4, s38, v4
  v_and_b32 v25, 7, v0
  v_lshlrev_b32 v25, 8, v25
  v_lshrrev_b32 v27, 3, v27
  v_lshl_add_u32 v27, v26, 1, v27
  v_lshl_add_u32 v25, v27, 3, v25
  s_mov_b32 s40, 0xff00ff00
  s_mov_b32 s41, 0xff00ff00
  s_mov_b32 s42, 0
  s_mov_b32 s43, -1
  s_mov_b32 s44, 0x3fb8aa3b
  s_mov_b32 s45, 0x3db504f3
  v_mov_b32 v24, 0xff800000
  s_cmp_lt_u32 s3, 4
  s_cbranch_scc0 L_notab
  s_lshl_b32 s38, s3, 12
  v_lshlrev_b32 v27, 6, v0
  v_add_u32 v27, s38, v27
  v_mov_b32 v124, 0
  v_mov_b32 v125, 0
  v_mov_b32 v126, 0
  v_mov_b32 v127, 0
  v_mov_b32 v28, 51712
  ds_write_b128 v28, v[124:127]
  ds_write_b128 v28, v[124:127] offset:16
  s_waitcnt vmcnt(16)
  v_lshlrev_b32 v108, 16, v96
  v_and_b32 v109, 0xffff0000, v96
  v_lshlrev_b32 v110, 16, v100
  v_and_b32 v111, 0xffff0000, v100
  v_mul_f32 v110, -v110, v108
  v_mul_f32 v111, -v111, v109
  ds_write_b128 v27, v[108:111] offset:0
  v_lshlrev_b32 v112, 16, v97
  v_and_b32 v113, 0xffff0000, v97
  v_lshlrev_b32 v114, 16, v101
  v_and_b32 v115, 0xffff0000, v101
  v_mul_f32 v114, -v114, v112
  v_mul_f32 v115, -v115, v113
  ds_write_b128 v27, v[112:115] offset:16
  v_lshlrev_b32 v116, 16, v98
  v_and_b32 v117, 0xffff0000, v98
  v_lshlrev_b32 v118, 16, v102
  v_and_b32 v119, 0xffff0000, v102
  v_mul_f32 v118, -v118, v116
  v_mul_f32 v119, -v119, v117
  ds_write_b128 v27, v[116:119] offset:32
  v_lshlrev_b32 v120, 16, v99
  v_and_b32 v121, 0xffff0000, v99
  v_lshlrev_b32 v122, 16, v103
  v_and_b32 v123, 0xffff0000, v103
  v_mul_f32 v122, -v122, v120
  v_mul_f32 v123, -v123, v121
  ds_write_b128 v27, v[120:123] offset:48
  s_cmp_lt_u32 s3, 2
  s_cbranch_scc0 L_notab
  s_lshl_b32 s38, s3, 10
  v_add_u32 v29, s38, v29
  ds_write_b128 v29, v[104:107] offset:16384
L_notab:
  s_waitcnt lgkmcnt(0)
  s_barrier
  ds_read_b64 v[16:17], v25 offset:16384
  ds_read_b64 v[18:19], v25 offset:16448
  ds_read_b64 v[20:21], v25 offset:16512
  ds_read_b64 v[22:23], v25 offset:16576
  s_lshr_b32 s46, s67, 6
  s_add_u32 s46, s46, 0
  s_and_b32 s46, s46, 0x1fff
  v_add_u32 v5, s46, v3
  ds_read_b128 v[152:155], v5 offset:0
  ds_read_b128 v[156:159], v5 offset:16
  ds_read_b128 v[160:163], v5 offset:256
  ds_read_b128 v[164:167], v5 offset:272
  ds_read_b128 v[168:171], v5 offset:512
  ds_read_b128 v[172:175], v5 offset:528
  ds_read_b128 v[176:179], v5 offset:768
  ds_read_b128 v[180:183], v5 offset:784
  s_waitcnt vmcnt(12)
  v_cvt_f32_i32 v96, v32
  v_cvt_f32_i32 v97, v33
  v_cvt_f32_i32 v98, v34
  v_cvt_f32_i32 v99, v35
  v_cvt_f32_i32 v100, v36
  v_cvt_f32_i32 v101, v37
  v_cvt_f32_i32 v102, v38
  v_cvt_f32_i32 v103, v39
  v_cvt_f32_i32 v104, v40
  v_cvt_f32_i32 v105, v41
  v_cvt_f32_i32 v106, v42
  v_cvt_f32_i32 v107, v43
  v_cvt_f32_i32 v108, v44
  v_cvt_f32_i32 v109, v45
  v_cvt_f32_i32 v110, v46
  v_cvt_f32_i32 v111, v47
  buffer_load_dwordx4 v[32:35], v1, s[24:27], s36 offen offset:0 nt
  buffer_load_dwordx4 v[36:39], v1, s[24:27], s36 offen offset:128 nt
  buffer_load_dwordx4 v[40:43], v1, s[24:27], s36 offen offset:256 nt
  buffer_load_dwordx4 v[44:47], v1, s[24:27], s36 offen offset:384 nt
  s_add_u32 s37, s37, 32768
  s_and_b32 s37, s37, 0x7ffff
  s_add_u32 s36, s69, s37
  s_waitcnt lgkmcnt(0)
  v_pk_fma_f32 v[96:97], v[96:97], v[152:153], v[154:155]
  v_pk_fma_f32 v[98:99], v[98:99], v[156:157], v[158:159]
  v_pk_fma_f32 v[100:101], v[100:101], v[160:161], v[162:163]
  v_pk_fma_f32 v[102:103], v[102:103], v[164:165], v[166:167]
  v_pk_fma_f32 v[104:105], v[104:105], v[168:169], v[170:171]
  v_pk_fma_f32 v[106:107], v[106:107], v[172:173], v[174:175]
  v_pk_fma_f32 v[108:109], v[108:109], v[176:177], v[178:179]
  v_pk_fma_f32 v[110:111], v[110:111], v[180:181], v[182:183]
  s_lshr_b32 s46, s67, 6
  s_add_u32 s46, s46, 1024
  s_and_b32 s46, s46, 0x1fff
  v_add_u32 v5, s46, v3
  ds_read_b128 v[184:187], v5 offset:0
  ds_read_b128 v[188:191], v5 offset:16
  ds_read_b128 v[192:195], v5 offset:256
  ds_read_b128 v[196:199], v5 offset:272
  ds_read_b128 v[200:203], v5 offset:512
  ds_read_b128 v[204:207], v5 offset:528
  ds_read_b128 v[208:211], v5 offset:768
  ds_read_b128 v[212:215], v5 offset:784
  v_cvt_pk_bf16_f32 v128, v96, v97
  v_cvt_pk_bf16_f32 v129, v98, v99
  v_cvt_pk_bf16_f32 v130, v100, v101
  v_cvt_pk_bf16_f32 v131, v102, v103
  v_cvt_pk_bf16_f32 v132, v104, v105
  v_cvt_pk_bf16_f32 v133, v106, v107
  v_cvt_pk_bf16_f32 v134, v108, v109
  v_cvt_pk_bf16_f32 v135, v110, v111
  v_mfma_f32_16x16x32_bf16 v[144:147], v[128:131], v[16:19], 0
  s_nop 0
  v_mfma_f32_16x16x32_bf16 v[144:147], v[132:135], v[20:23], v[144:147]
  s_waitcnt vmcnt(12)
  v_cvt_f32_i32 v112, v48
  v_cvt_f32_i32 v113, v49
  v_cvt_f32_i32 v114, v50
  v_cvt_f32_i32 v115, v51
  v_cvt_f32_i32 v116, v52
  v_cvt_f32_i32 v117, v53
  v_cvt_f32_i32 v118, v54
  v_cvt_f32_i32 v119, v55
  v_cvt_f32_i32 v120, v56
  v_cvt_f32_i32 v121, v57
  v_cvt_f32_i32 v122, v58
  v_cvt_f32_i32 v123, v59
  v_cvt_f32_i32 v124, v60
  v_cvt_f32_i32 v125, v61
  v_cvt_f32_i32 v126, v62
  v_cvt_f32_i32 v127, v63
  buffer_load_dwordx4 v[48:51], v1, s[24:27], s36 offen offset:0 nt
  buffer_load_dwordx4 v[52:55], v1, s[24:27], s36 offen offset:128 nt
  buffer_load_dwordx4 v[56:59], v1, s[24:27], s36 offen offset:256 nt
  buffer_load_dwordx4 v[60:63], v1, s[24:27], s36 offen offset:384 nt
  s_add_u32 s37, s37, 32768
  s_and_b32 s37, s37, 0x7ffff
  s_add_u32 s36, s69, s37
  v_pk_fma_f32 v[112:113], v[112:113], v[152:153], v[154:155]
  v_pk_fma_f32 v[114:115], v[114:115], v[156:157], v[158:159]
  v_pk_fma_f32 v[116:117], v[116:117], v[160:161], v[162:163]
  v_pk_fma_f32 v[118:119], v[118:119], v[164:165], v[166:167]
  v_pk_fma_f32 v[120:121], v[120:121], v[168:169], v[170:171]
  v_pk_fma_f32 v[122:123], v[122:123], v[172:173], v[174:175]
  v_pk_fma_f32 v[124:125], v[124:125], v[176:177], v[178:179]
  v_pk_fma_f32 v[126:127], v[126:127], v[180:181], v[182:183]
  v_cvt_pk_bf16_f32 v136, v112, v113
  v_cvt_pk_bf16_f32 v137, v114, v115
  v_cvt_pk_bf16_f32 v138, v116, v117
  v_cvt_pk_bf16_f32 v139, v118, v119
  v_cvt_pk_bf16_f32 v140, v120, v121
  v_cvt_pk_bf16_f32 v141, v122, v123
  v_cvt_pk_bf16_f32 v142, v124, v125
  v_cvt_pk_bf16_f32 v143, v126, v127
  v_mfma_f32_16x16x32_bf16 v[148:151], v[136:139], v[16:19], 0
  s_nop 0
  v_mfma_f32_16x16x32_bf16 v[148:151], v[140:143], v[20:23], v[148:151]
  v_cndmask_b32 v216, v144, v145, s[40:41]
  v_cndmask_b32 v217, v146, v147, s[40:41]
  s_nop 0
  v_add_f32_dpp v216, v216, v216 row_ror:8 row_mask:0xf bank_mask:0xf
  v_add_f32_dpp v217, v217, v217 row_ror:8 row_mask:0xf bank_mask:0xf
  v_cvt_pk_bf16_f32 v26, v216, v217
  v_lshlrev_b32 v216, 16, v26
  v_and_b32 v217, 0xffff0000, v26
  v_mul_f32 v216, s45, v216
  v_mul_f32 v217, s45, v217
  v_cvt_pk_bf16_f32 v26, v216, v217
  v_lshlrev_b32 v216, 16, v26
  v_and_b32 v217, 0xffff0000, v26
  v_max3_f32 v24, v24, v216, v217
  s_waitcnt vmcnt(12)
  v_cvt_f32_i32 v96, v64
  v_cvt_f32_i32 v97, v65
  v_cvt_f32_i32 v98, v66
  v_cvt_f32_i32 v99, v67
  v_cvt_f32_i32 v100, v68
  v_cvt_f32_i32 v101, v69
  v_cvt_f32_i32 v102, v70
  v_cvt_f32_i32 v103, v71
  v_cvt_f32_i32 v104, v72
  v_cvt_f32_i32 v105, v73
  v_cvt_f32_i32 v106, v74
  v_cvt_f32_i32 v107, v75
  v_cvt_f32_i32 v108, v76
  v_cvt_f32_i32 v109, v77
  v_cvt_f32_i32 v110, v78
  v_cvt_f32_i32 v111, v79
  buffer_load_dwordx4 v[64:67], v1, s[24:27], s36 offen offset:0 nt
  buffer_load_dwordx4 v[68:71], v1, s[24:27], s36 offen offset:128 nt
  buffer_load_dwordx4 v[72:75], v1, s[24:27], s36 offen offset:256 nt
  buffer_load_dwordx4 v[76:79], v1, s[24:27], s36 offen offset:384 nt
  s_add_u32 s37, s37, 32768
  s_and_b32 s37, s37, 0x7ffff
  s_add_u32 s36, s69, s37
  s_waitcnt lgkmcnt(0)
  v_pk_fma_f32 v[96:97], v[96:97], v[184:185], v[186:187]
  v_pk_fma_f32 v[98:99], v[98:99], v[188:189], v[190:191]
  v_pk_fma_f32 v[100:101], v[100:101], v[192:193], v[194:195]
  v_pk_fma_f32 v[102:103], v[102:103], v[196:197], v[198:199]
  v_pk_fma_f32 v[104:105], v[104:105], v[200:201], v[202:203]
  v_pk_fma_f32 v[106:107], v[106:107], v[204:205], v[206:207]
  v_pk_fma_f32 v[108:109], v[108:109], v[208:209], v[210:211]
  v_pk_fma_f32 v[110:111], v[110:111], v[212:213], v[214:215]
  s_lshr_b32 s46, s67, 6
  s_add_u32 s46, s46, 2048
  s_and_b32 s46, s46, 0x1fff
  v_add_u32 v5, s46, v3
  ds_read_b128 v[152:155], v5 offset:0
  ds_read_b128 v[156:159], v5 offset:16
  ds_read_b128 v[160:163], v5 offset:256
  ds_read_b128 v[164:167], v5 offset:272
  ds_read_b128 v[168:171], v5 offset:512
  ds_read_b128 v[172:175], v5 offset:528
  ds_read_b128 v[176:179], v5 offset:768
  ds_read_b128 v[180:183], v5 offset:784
  v_cvt_pk_bf16_f32 v128, v96, v97
  v_cvt_pk_bf16_f32 v129, v98, v99
  v_cvt_pk_bf16_f32 v130, v100, v101
  v_cvt_pk_bf16_f32 v131, v102, v103
  v_cvt_pk_bf16_f32 v132, v104, v105
  v_cvt_pk_bf16_f32 v133, v106, v107
  v_cvt_pk_bf16_f32 v134, v108, v109
  v_cvt_pk_bf16_f32 v135, v110, v111
  v_mfma_f32_16x16x32_bf16 v[144:147], v[128:131], v[16:19], 0
  s_nop 0
  v_mfma_f32_16x16x32_bf16 v[144:147], v[132:135], v[20:23], v[144:147]
  v_cndmask_b32 v218, v148, v149, s[40:41]
  v_cndmask_b32 v219, v150, v151, s[40:41]
  s_nop 0
  v_add_f32_dpp v218, v218, v218 row_ror:8 row_mask:0xf bank_mask:0xf
  v_add_f32_dpp v219, v219, v219 row_ror:8 row_mask:0xf bank_mask:0xf
  v_cvt_pk_bf16_f32 v26, v218, v219
  v_lshlrev_b32 v218, 16, v26
  v_and_b32 v219, 0xffff0000, v26
  v_mul_f32 v218, s45, v218
  v_mul_f32 v219, s45, v219
  v_cvt_pk_bf16_f32 v26, v218, v219
  v_lshlrev_b32 v218, 16, v26
  v_and_b32 v219, 0xffff0000, v26
  v_max3_f32 v24, v24, v218, v219
  s_waitcnt vmcnt(12)
  v_cvt_f32_i32 v112, v80
  v_cvt_f32_i32 v113, v81
  v_cvt_f32_i32 v114, v82
  v_cvt_f32_i32 v115, v83
  v_cvt_f32_i32 v116, v84
  v_cvt_f32_i32 v117, v85
  v_cvt_f32_i32 v118, v86
  v_cvt_f32_i32 v119, v87
  v_cvt_f32_i32 v120, v88
  v_cvt_f32_i32 v121, v89
  v_cvt_f32_i32 v122, v90
  v_cvt_f32_i32 v123, v91
  v_cvt_f32_i32 v124, v92
  v_cvt_f32_i32 v125, v93
  v_cvt_f32_i32 v126, v94
  v_cvt_f32_i32 v127, v95
  buffer_load_dwordx4 v[80:83], v1, s[24:27], s36 offen offset:0 nt
  buffer_load_dwordx4 v[84:87], v1, s[24:27], s36 offen offset:128 nt
  buffer_load_dwordx4 v[88:91], v1, s[24:27], s36 offen offset:256 nt
  buffer_load_dwordx4 v[92:95], v1, s[24:27], s36 offen offset:384 nt
  s_add_u32 s37, s37, 32768
  s_and_b32 s37, s37, 0x7ffff
  s_add_u32 s36, s69, s37
  v_pk_fma_f32 v[112:113], v[112:113], v[184:185], v[186:187]
  v_pk_fma_f32 v[114:115], v[114:115], v[188:189], v[190:191]
  v_pk_fma_f32 v[116:117], v[116:117], v[192:193], v[194:195]
  v_pk_fma_f32 v[118:119], v[118:119], v[196:197], v[198:199]
  v_pk_fma_f32 v[120:121], v[120:121], v[200:201], v[202:203]
  v_pk_fma_f32 v[122:123], v[122:123], v[204:205], v[206:207]
  v_pk_fma_f32 v[124:125], v[124:125], v[208:209], v[210:211]
  v_pk_fma_f32 v[126:127], v[126:127], v[212:213], v[214:215]
  v_cvt_pk_bf16_f32 v136, v112, v113
  v_cvt_pk_bf16_f32 v137, v114, v115
  v_cvt_pk_bf16_f32 v138, v116, v117
  v_cvt_pk_bf16_f32 v139, v118, v119
  v_cvt_pk_bf16_f32 v140, v120, v121
  v_cvt_pk_bf16_f32 v141, v122, v123
  v_cvt_pk_bf16_f32 v142, v124, v125
  v_cvt_pk_bf16_f32 v143, v126, v127
  v_mfma_f32_16x16x32_bf16 v[148:151], v[136:139], v[16:19], 0
  s_nop 0
  v_mfma_f32_16x16x32_bf16 v[148:151], v[140:143], v[20:23], v[148:151]
  v_cndmask_b32 v220, v144, v145, s[40:41]
  v_cndmask_b32 v221, v146, v147, s[40:41]
  s_nop 0
  v_add_f32_dpp v220, v220, v220 row_ror:8 row_mask:0xf bank_mask:0xf
  v_add_f32_dpp v221, v221, v221 row_ror:8 row_mask:0xf bank_mask:0xf
  v_cvt_pk_bf16_f32 v26, v220, v221
  v_lshlrev_b32 v220, 16, v26
  v_and_b32 v221, 0xffff0000, v26
  v_mul_f32 v220, s45, v220
  v_mul_f32 v221, s45, v221
  v_cvt_pk_bf16_f32 v26, v220, v221
  v_lshlrev_b32 v220, 16, v26
  v_and_b32 v221, 0xffff0000, v26
  v_max3_f32 v24, v24, v220, v221
  s_waitcnt vmcnt(12)
  v_cvt_f32_i32 v96, v32
  v_cvt_f32_i32 v97, v33
  v_cvt_f32_i32 v98, v34
  v_cvt_f32_i32 v99, v35
  v_cvt_f32_i32 v100, v36
  v_cvt_f32_i32 v101, v37
  v_cvt_f32_i32 v102, v38
  v_cvt_f32_i32 v103, v39
  v_cvt_f32_i32 v104, v40
  v_cvt_f32_i32 v105, v41
  v_cvt_f32_i32 v106, v42
  v_cvt_f32_i32 v107, v43
  v_cvt_f32_i32 v108, v44
  v_cvt_f32_i32 v109, v45
  v_cvt_f32_i32 v110, v46
  v_cvt_f32_i32 v111, v47
  buffer_load_dwordx4 v[32:35], v1, s[24:27], s36 offen offset:0 nt
  buffer_load_dwordx4 v[36:39], v1, s[24:27], s36 offen offset:128 nt
  buffer_load_dwordx4 v[40:43], v1, s[24:27], s36 offen offset:256 nt
  buffer_load_dwordx4 v[44:47], v1, s[24:27], s36 offen offset:384 nt
  s_add_u32 s37, s37, 32768
  s_and_b32 s37, s37, 0x7ffff
  s_add_u32 s36, s69, s37
  s_waitcnt lgkmcnt(0)
  v_pk_fma_f32 v[96:97], v[96:97], v[152:153], v[154:155]
  v_pk_fma_f32 v[98:99], v[98:99], v[156:157], v[158:159]
  v_pk_fma_f32 v[100:101], v[100:101], v[160:161], v[162:163]
  v_pk_fma_f32 v[102:103], v[102:103], v[164:165], v[166:167]
  v_pk_fma_f32 v[104:105], v[104:105], v[168:169], v[170:171]
  v_pk_fma_f32 v[106:107], v[106:107], v[172:173], v[174:175]
  v_pk_fma_f32 v[108:109], v[108:109], v[176:177], v[178:179]
  v_pk_fma_f32 v[110:111], v[110:111], v[180:181], v[182:183]
  s_lshr_b32 s46, s67, 6
  s_add_u32 s46, s46, 3072
  s_and_b32 s46, s46, 0x1fff
  v_add_u32 v5, s46, v3
  ds_read_b128 v[184:187], v5 offset:0
  ds_read_b128 v[188:191], v5 offset:16
  ds_read_b128 v[192:195], v5 offset:256
  ds_read_b128 v[196:199], v5 offset:272
  ds_read_b128 v[200:203], v5 offset:512
  ds_read_b128 v[204:207], v5 offset:528
  ds_read_b128 v[208:211], v5 offset:768
  ds_read_b128 v[212:215], v5 offset:784
  v_cvt_pk_bf16_f32 v128, v96, v97
  v_cvt_pk_bf16_f32 v129, v98, v99
  v_cvt_pk_bf16_f32 v130, v100, v101
  v_cvt_pk_bf16_f32 v131, v102, v103
  v_cvt_pk_bf16_f32 v132, v104, v105
  v_cvt_pk_bf16_f32 v133, v106, v107
  v_cvt_pk_bf16_f32 v134, v108, v109
  v_cvt_pk_bf16_f32 v135, v110, v111
  v_mfma_f32_16x16x32_bf16 v[144:147], v[128:131], v[16:19], 0
  s_nop 0
  v_mfma_f32_16x16x32_bf16 v[144:147], v[132:135], v[20:23], v[144:147]
  v_cndmask_b32 v222, v148, v149, s[40:41]
  v_cndmask_b32 v223, v150, v151, s[40:41]
  s_nop 0
  v_add_f32_dpp v222, v222, v222 row_ror:8 row_mask:0xf bank_mask:0xf
  v_add_f32_dpp v223, v223, v223 row_ror:8 row_mask:0xf bank_mask:0xf
  v_cvt_pk_bf16_f32 v26, v222, v223
  v_lshlrev_b32 v222, 16, v26
  v_and_b32 v223, 0xffff0000, v26
  v_mul_f32 v222, s45, v222
  v_mul_f32 v223, s45, v223
  v_cvt_pk_bf16_f32 v26, v222, v223
  v_lshlrev_b32 v222, 16, v26
  v_and_b32 v223, 0xffff0000, v26
  v_max3_f32 v24, v24, v222, v223
  s_waitcnt vmcnt(12)
  v_cvt_f32_i32 v112, v48
  v_cvt_f32_i32 v113, v49
  v_cvt_f32_i32 v114, v50
  v_cvt_f32_i32 v115, v51
  v_cvt_f32_i32 v116, v52
  v_cvt_f32_i32 v117, v53
  v_cvt_f32_i32 v118, v54
  v_cvt_f32_i32 v119, v55
  v_cvt_f32_i32 v120, v56
  v_cvt_f32_i32 v121, v57
  v_cvt_f32_i32 v122, v58
  v_cvt_f32_i32 v123, v59
  v_cvt_f32_i32 v124, v60
  v_cvt_f32_i32 v125, v61
  v_cvt_f32_i32 v126, v62
  v_cvt_f32_i32 v127, v63
  buffer_load_dwordx4 v[48:51], v1, s[24:27], s36 offen offset:0 nt
  buffer_load_dwordx4 v[52:55], v1, s[24:27], s36 offen offset:128 nt
  buffer_load_dwordx4 v[56:59], v1, s[24:27], s36 offen offset:256 nt
  buffer_load_dwordx4 v[60:63], v1, s[24:27], s36 offen offset:384 nt
  s_add_u32 s37, s37, 32768
  s_and_b32 s37, s37, 0x7ffff
  s_add_u32 s36, s69, s37
  v_pk_fma_f32 v[112:113], v[112:113], v[152:153], v[154:155]
  v_pk_fma_f32 v[114:115], v[114:115], v[156:157], v[158:159]
  v_pk_fma_f32 v[116:117], v[116:117], v[160:161], v[162:163]
  v_pk_fma_f32 v[118:119], v[118:119], v[164:165], v[166:167]
  v_pk_fma_f32 v[120:121], v[120:121], v[168:169], v[170:171]
  v_pk_fma_f32 v[122:123], v[122:123], v[172:173], v[174:175]
  v_pk_fma_f32 v[124:125], v[124:125], v[176:177], v[178:179]
  v_pk_fma_f32 v[126:127], v[126:127], v[180:181], v[182:183]
  v_cvt_pk_bf16_f32 v136, v112, v113
  v_cvt_pk_bf16_f32 v137, v114, v115
  v_cvt_pk_bf16_f32 v138, v116, v117
  v_cvt_pk_bf16_f32 v139, v118, v119
  v_cvt_pk_bf16_f32 v140, v120, v121
  v_cvt_pk_bf16_f32 v141, v122, v123
  v_cvt_pk_bf16_f32 v142, v124, v125
  v_cvt_pk_bf16_f32 v143, v126, v127
  v_mfma_f32_16x16x32_bf16 v[148:151], v[136:139], v[16:19], 0
  s_nop 0
  v_mfma_f32_16x16x32_bf16 v[148:151], v[140:143], v[20:23], v[148:151]
  v_cndmask_b32 v224, v144, v145, s[40:41]
  v_cndmask_b32 v225, v146, v147, s[40:41]
  s_nop 0
  v_add_f32_dpp v224, v224, v224 row_ror:8 row_mask:0xf bank_mask:0xf
  v_add_f32_dpp v225, v225, v225 row_ror:8 row_mask:0xf bank_mask:0xf
  v_cvt_pk_bf16_f32 v26, v224, v225
  v_lshlrev_b32 v224, 16, v26
  v_and_b32 v225, 0xffff0000, v26
  v_mul_f32 v224, s45, v224
  v_mul_f32 v225, s45, v225
  v_cvt_pk_bf16_f32 v26, v224, v225
  v_lshlrev_b32 v224, 16, v26
  v_and_b32 v225, 0xffff0000, v26
  v_max3_f32 v24, v24, v224, v225
  s_waitcnt vmcnt(12)
  v_cvt_f32_i32 v96, v64
  v_cvt_f32_i32 v97, v65
  v_cvt_f32_i32 v98, v66
  v_cvt_f32_i32 v99, v67
  v_cvt_f32_i32 v100, v68
  v_cvt_f32_i32 v101, v69
  v_cvt_f32_i32 v102, v70
  v_cvt_f32_i32 v103, v71
  v_cvt_f32_i32 v104, v72
  v_cvt_f32_i32 v105, v73
  v_cvt_f32_i32 v106, v74
  v_cvt_f32_i32 v107, v75
  v_cvt_f32_i32 v108, v76
  v_cvt_f32_i32 v109, v77
  v_cvt_f32_i32 v110, v78
  v_cvt_f32_i32 v111, v79
  buffer_load_dwordx4 v[64:67], v1, s[24:27], s36 offen offset:0 nt
  buffer_load_dwordx4 v[68:71], v1, s[24:27], s36 offen offset:128 nt
  buffer_load_dwordx4 v[72:75], v1, s[24:27], s36 offen offset:256 nt
  buffer_load_dwordx4 v[76:79], v1, s[24:27], s36 offen offset:384 nt
  s_add_u32 s37, s37, 32768
  s_and_b32 s37, s37, 0x7ffff
  s_add_u32 s36, s69, s37
  s_waitcnt lgkmcnt(0)
  v_pk_fma_f32 v[96:97], v[96:97], v[184:185], v[186:187]
  v_pk_fma_f32 v[98:99], v[98:99], v[188:189], v[190:191]
  v_pk_fma_f32 v[100:101], v[100:101], v[192:193], v[194:195]
  v_pk_fma_f32 v[102:103], v[102:103], v[196:197], v[198:199]
  v_pk_fma_f32 v[104:105], v[104:105], v[200:201], v[202:203]
  v_pk_fma_f32 v[106:107], v[106:107], v[204:205], v[206:207]
  v_pk_fma_f32 v[108:109], v[108:109], v[208:209], v[210:211]
  v_pk_fma_f32 v[110:111], v[110:111], v[212:213], v[214:215]
  s_lshr_b32 s46, s67, 6
  s_add_u32 s46, s46, 4096
  s_and_b32 s46, s46, 0x1fff
  v_add_u32 v5, s46, v3
  ds_read_b128 v[152:155], v5 offset:0
  ds_read_b128 v[156:159], v5 offset:16
  ds_read_b128 v[160:163], v5 offset:256
  ds_read_b128 v[164:167], v5 offset:272
  ds_read_b128 v[168:171], v5 offset:512
  ds_read_b128 v[172:175], v5 offset:528
  ds_read_b128 v[176:179], v5 offset:768
  ds_read_b128 v[180:183], v5 offset:784
  v_cvt_pk_bf16_f32 v128, v96, v97
  v_cvt_pk_bf16_f32 v129, v98, v99
  v_cvt_pk_bf16_f32 v130, v100, v101
  v_cvt_pk_bf16_f32 v131, v102, v103
  v_cvt_pk_bf16_f32 v132, v104, v105
  v_cvt_pk_bf16_f32 v133, v106, v107
  v_cvt_pk_bf16_f32 v134, v108, v109
  v_cvt_pk_bf16_f32 v135, v110, v111
  v_mfma_f32_16x16x32_bf16 v[144:147], v[128:131], v[16:19], 0
  s_nop 0
  v_mfma_f32_16x16x32_bf16 v[144:147], v[132:135], v[20:23], v[144:147]
  v_cndmask_b32 v226, v148, v149, s[40:41]
  v_cndmask_b32 v227, v150, v151, s[40:41]
  s_nop 0
  v_add_f32_dpp v226, v226, v226 row_ror:8 row_mask:0xf bank_mask:0xf
  v_add_f32_dpp v227, v227, v227 row_ror:8 row_mask:0xf bank_mask:0xf
  v_cvt_pk_bf16_f32 v26, v226, v227
  v_lshlrev_b32 v226, 16, v26
  v_and_b32 v227, 0xffff0000, v26
  v_mul_f32 v226, s45, v226
  v_mul_f32 v227, s45, v227
  v_cvt_pk_bf16_f32 v26, v226, v227
  v_lshlrev_b32 v226, 16, v26
  v_and_b32 v227, 0xffff0000, v26
  v_max3_f32 v24, v24, v226, v227
  s_waitcnt vmcnt(12)
  v_cvt_f32_i32 v112, v80
  v_cvt_f32_i32 v113, v81
  v_cvt_f32_i32 v114, v82
  v_cvt_f32_i32 v115, v83
  v_cvt_f32_i32 v116, v84
  v_cvt_f32_i32 v117, v85
  v_cvt_f32_i32 v118, v86
  v_cvt_f32_i32 v119, v87
  v_cvt_f32_i32 v120, v88
  v_cvt_f32_i32 v121, v89
  v_cvt_f32_i32 v122, v90
  v_cvt_f32_i32 v123, v91
  v_cvt_f32_i32 v124, v92
  v_cvt_f32_i32 v125, v93
  v_cvt_f32_i32 v126, v94
  v_cvt_f32_i32 v127, v95
  buffer_load_dwordx4 v[80:83], v1, s[24:27], s36 offen offset:0 nt
  buffer_load_dwordx4 v[84:87], v1, s[24:27], s36 offen offset:128 nt
  buffer_load_dwordx4 v[88:91], v1, s[24:27], s36 offen offset:256 nt
  buffer_load_dwordx4 v[92:95], v1, s[24:27], s36 offen offset:384 nt
  s_add_u32 s37, s37, 32768
  s_and_b32 s37, s37, 0x7ffff
  s_add_u32 s36, s69, s37
  v_pk_fma_f32 v[112:113], v[112:113], v[184:185], v[186:187]
  v_pk_fma_f32 v[114:115], v[114:115], v[188:189], v[190:191]
  v_pk_fma_f32 v[116:117], v[116:117], v[192:193], v[194:195]
  v_pk_fma_f32 v[118:119], v[118:119], v[196:197], v[198:199]
  v_pk_fma_f32 v[120:121], v[120:121], v[200:201], v[202:203]
  v_pk_fma_f32 v[122:123], v[122:123], v[204:205], v[206:207]
  v_pk_fma_f32 v[124:125], v[124:125], v[208:209], v[210:211]
  v_pk_fma_f32 v[126:127], v[126:127], v[212:213], v[214:215]
  v_cvt_pk_bf16_f32 v136, v112, v113
  v_cvt_pk_bf16_f32 v137, v114, v115
  v_cvt_pk_bf16_f32 v138, v116, v117
  v_cvt_pk_bf16_f32 v139, v118, v119
  v_cvt_pk_bf16_f32 v140, v120, v121
  v_cvt_pk_bf16_f32 v141, v122, v123
  v_cvt_pk_bf16_f32 v142, v124, v125
  v_cvt_pk_bf16_f32 v143, v126, v127
  v_mfma_f32_16x16x32_bf16 v[148:151], v[136:139], v[16:19], 0
  s_nop 0
  v_mfma_f32_16x16x32_bf16 v[148:151], v[140:143], v[20:23], v[148:151]
  v_cndmask_b32 v228, v144, v145, s[40:41]
  v_cndmask_b32 v229, v146, v147, s[40:41]
  s_nop 0
  v_add_f32_dpp v228, v228, v228 row_ror:8 row_mask:0xf bank_mask:0xf
  v_add_f32_dpp v229, v229, v229 row_ror:8 row_mask:0xf bank_mask:0xf
  v_cvt_pk_bf16_f32 v26, v228, v229
  v_lshlrev_b32 v228, 16, v26
  v_and_b32 v229, 0xffff0000, v26
  v_mul_f32 v228, s45, v228
  v_mul_f32 v229, s45, v229
  v_cvt_pk_bf16_f32 v26, v228, v229
  v_lshlrev_b32 v228, 16, v26
  v_and_b32 v229, 0xffff0000, v26
  v_max3_f32 v24, v24, v228, v229
  s_waitcnt vmcnt(12)
  v_cvt_f32_i32 v96, v32
  v_cvt_f32_i32 v97, v33
  v_cvt_f32_i32 v98, v34
  v_cvt_f32_i32 v99, v35
  v_cvt_f32_i32 v100, v36
  v_cvt_f32_i32 v101, v37
  v_cvt_f32_i32 v102, v38
  v_cvt_f32_i32 v103, v39
  v_cvt_f32_i32 v104, v40
  v_cvt_f32_i32 v105, v41
  v_cvt_f32_i32 v106, v42
  v_cvt_f32_i32 v107, v43
  v_cvt_f32_i32 v108, v44
  v_cvt_f32_i32 v109, v45
  v_cvt_f32_i32 v110, v46
  v_cvt_f32_i32 v111, v47
  buffer_load_dwordx4 v[32:35], v1, s[24:27], s36 offen offset:0 nt
  buffer_load_dwordx4 v[36:39], v1, s[24:27], s36 offen offset:128 nt
  buffer_load_dwordx4 v[40:43], v1, s[24:27], s36 offen offset:256 nt
  buffer_load_dwordx4 v[44:47], v1, s[24:27], s36 offen offset:384 nt
  s_add_u32 s37, s37, 32768
  s_and_b32 s37, s37, 0x7ffff
  s_add_u32 s36, s69, s37
  s_waitcnt lgkmcnt(0)
  v_pk_fma_f32 v[96:97], v[96:97], v[152:153], v[154:155]
  v_pk_fma_f32 v[98:99], v[98:99], v[156:157], v[158:159]
  v_pk_fma_f32 v[100:101], v[100:101], v[160:161], v[162:163]
  v_pk_fma_f32 v[102:103], v[102:103], v[164:165], v[166:167]
  v_pk_fma_f32 v[104:105], v[104:105], v[168:169], v[170:171]
  v_pk_fma_f32 v[106:107], v[106:107], v[172:173], v[174:175]
  v_pk_fma_f32 v[108:109], v[108:109], v[176:177], v[178:179]
  v_pk_fma_f32 v[110:111], v[110:111], v[180:181], v[182:183]
  s_lshr_b32 s46, s67, 6
  s_add_u32 s46, s46, 5120
  s_and_b32 s46, s46, 0x1fff
  v_add_u32 v5, s46, v3
  ds_read_b128 v[184:187], v5 offset:0
  ds_read_b128 v[188:191], v5 offset:16
  ds_read_b128 v[192:195], v5 offset:256
  ds_read_b128 v[196:199], v5 offset:272
  ds_read_b128 v[200:203], v5 offset:512
  ds_read_b128 v[204:207], v5 offset:528
  ds_read_b128 v[208:211], v5 offset:768
  ds_read_b128 v[212:215], v5 offset:784
  v_cvt_pk_bf16_f32 v128, v96, v97
  v_cvt_pk_bf16_f32 v129, v98, v99
  v_cvt_pk_bf16_f32 v130, v100, v101
  v_cvt_pk_bf16_f32 v131, v102, v103
  v_cvt_pk_bf16_f32 v132, v104, v105
  v_cvt_pk_bf16_f32 v133, v106, v107
  v_cvt_pk_bf16_f32 v134, v108, v109
  v_cvt_pk_bf16_f32 v135, v110, v111
  v_mfma_f32_16x16x32_bf16 v[144:147], v[128:131], v[16:19], 0
  s_nop 0
  v_mfma_f32_16x16x32_bf16 v[144:147], v[132:135], v[20:23], v[144:147]
  v_cndmask_b32 v230, v148, v149, s[40:41]
  v_cndmask_b32 v231, v150, v151, s[40:41]
  s_nop 0
  v_add_f32_dpp v230, v230, v230 row_ror:8 row_mask:0xf bank_mask:0xf
  v_add_f32_dpp v231, v231, v231 row_ror:8 row_mask:0xf bank_mask:0xf
  v_cvt_pk_bf16_f32 v26, v230, v231
  v_lshlrev_b32 v230, 16, v26
  v_and_b32 v231, 0xffff0000, v26
  v_mul_f32 v230, s45, v230
  v_mul_f32 v231, s45, v231
  v_cvt_pk_bf16_f32 v26, v230, v231
  v_lshlrev_b32 v230, 16, v26
  v_and_b32 v231, 0xffff0000, v26
  v_max3_f32 v24, v24, v230, v231
  s_waitcnt vmcnt(12)
  v_cvt_f32_i32 v112, v48
  v_cvt_f32_i32 v113, v49
  v_cvt_f32_i32 v114, v50
  v_cvt_f32_i32 v115, v51
  v_cvt_f32_i32 v116, v52
  v_cvt_f32_i32 v117, v53
  v_cvt_f32_i32 v118, v54
  v_cvt_f32_i32 v119, v55
  v_cvt_f32_i32 v120, v56
  v_cvt_f32_i32 v121, v57
  v_cvt_f32_i32 v122, v58
  v_cvt_f32_i32 v123, v59
  v_cvt_f32_i32 v124, v60
  v_cvt_f32_i32 v125, v61
  v_cvt_f32_i32 v126, v62
  v_cvt_f32_i32 v127, v63
  buffer_load_dwordx4 v[48:51], v1, s[24:27], s36 offen offset:0 nt
  buffer_load_dwordx4 v[52:55], v1, s[24:27], s36 offen offset:128 nt
  buffer_load_dwordx4 v[56:59], v1, s[24:27], s36 offen offset:256 nt
  buffer_load_dwordx4 v[60:63], v1, s[24:27], s36 offen offset:384 nt
  s_add_u32 s37, s37, 32768
  s_and_b32 s37, s37, 0x7ffff
  s_add_u32 s36, s69, s37
  v_pk_fma_f32 v[112:113], v[112:113], v[152:153], v[154:155]
  v_pk_fma_f32 v[114:115], v[114:115], v[156:157], v[158:159]
  v_pk_fma_f32 v[116:117], v[116:117], v[160:161], v[162:163]
  v_pk_fma_f32 v[118:119], v[118:119], v[164:165], v[166:167]
  v_pk_fma_f32 v[120:121], v[120:121], v[168:169], v[170:171]
  v_pk_fma_f32 v[122:123], v[122:123], v[172:173], v[174:175]
  v_pk_fma_f32 v[124:125], v[124:125], v[176:177], v[178:179]
  v_pk_fma_f32 v[126:127], v[126:127], v[180:181], v[182:183]
  v_cvt_pk_bf16_f32 v136, v112, v113
  v_cvt_pk_bf16_f32 v137, v114, v115
  v_cvt_pk_bf16_f32 v138, v116, v117
  v_cvt_pk_bf16_f32 v139, v118, v119
  v_cvt_pk_bf16_f32 v140, v120, v121
  v_cvt_pk_bf16_f32 v141, v122, v123
  v_cvt_pk_bf16_f32 v142, v124, v125
  v_cvt_pk_bf16_f32 v143, v126, v127
  v_mfma_f32_16x16x32_bf16 v[148:151], v[136:139], v[16:19], 0
  s_nop 0
  v_mfma_f32_16x16x32_bf16 v[148:151], v[140:143], v[20:23], v[148:151]
  v_cndmask_b32 v232, v144, v145, s[40:41]
  v_cndmask_b32 v233, v146, v147, s[40:41]
  s_nop 0
  v_add_f32_dpp v232, v232, v232 row_ror:8 row_mask:0xf bank_mask:0xf
  v_add_f32_dpp v233, v233, v233 row_ror:8 row_mask:0xf bank_mask:0xf
  v_cvt_pk_bf16_f32 v26, v232, v233
  v_lshlrev_b32 v232, 16, v26
  v_and_b32 v233, 0xffff0000, v26
  v_mul_f32 v232, s45, v232
  v_mul_f32 v233, s45, v233
  v_cvt_pk_bf16_f32 v26, v232, v233
  v_lshlrev_b32 v232, 16, v26
  v_and_b32 v233, 0xffff0000, v26
  v_max3_f32 v24, v24, v232, v233
  s_waitcnt vmcnt(12)
  v_cvt_f32_i32 v96, v64
  v_cvt_f32_i32 v97, v65
  v_cvt_f32_i32 v98, v66
  v_cvt_f32_i32 v99, v67
  v_cvt_f32_i32 v100, v68
  v_cvt_f32_i32 v101, v69
  v_cvt_f32_i32 v102, v70
  v_cvt_f32_i32 v103, v71
  v_cvt_f32_i32 v104, v72
  v_cvt_f32_i32 v105, v73
  v_cvt_f32_i32 v106, v74
  v_cvt_f32_i32 v107, v75
  v_cvt_f32_i32 v108, v76
  v_cvt_f32_i32 v109, v77
  v_cvt_f32_i32 v110, v78
  v_cvt_f32_i32 v111, v79
  buffer_load_dwordx4 v[64:67], v1, s[24:27], s36 offen offset:0 nt
  buffer_load_dwordx4 v[68:71], v1, s[24:27], s36 offen offset:128 nt
  buffer_load_dwordx4 v[72:75], v1, s[24:27], s36 offen offset:256 nt
  buffer_load_dwordx4 v[76:79], v1, s[24:27], s36 offen offset:384 nt
  s_add_u32 s37, s37, 32768
  s_and_b32 s37, s37, 0x7ffff
  s_add_u32 s36, s69, s37
  s_waitcnt lgkmcnt(0)
  v_pk_fma_f32 v[96:97], v[96:97], v[184:185], v[186:187]
  v_pk_fma_f32 v[98:99], v[98:99], v[188:189], v[190:191]
  v_pk_fma_f32 v[100:101], v[100:101], v[192:193], v[194:195]
  v_pk_fma_f32 v[102:103], v[102:103], v[196:197], v[198:199]
  v_pk_fma_f32 v[104:105], v[104:105], v[200:201], v[202:203]
  v_pk_fma_f32 v[106:107], v[106:107], v[204:205], v[206:207]
  v_pk_fma_f32 v[108:109], v[108:109], v[208:209], v[210:211]
  v_pk_fma_f32 v[110:111], v[110:111], v[212:213], v[214:215]
  s_lshr_b32 s46, s67, 6
  s_add_u32 s46, s46, 6144
  s_and_b32 s46, s46, 0x1fff
  v_add_u32 v5, s46, v3
  ds_read_b128 v[152:155], v5 offset:0
  ds_read_b128 v[156:159], v5 offset:16
  ds_read_b128 v[160:163], v5 offset:256
  ds_read_b128 v[164:167], v5 offset:272
  ds_read_b128 v[168:171], v5 offset:512
  ds_read_b128 v[172:175], v5 offset:528
  ds_read_b128 v[176:179], v5 offset:768
  ds_read_b128 v[180:183], v5 offset:784
  v_cvt_pk_bf16_f32 v128, v96, v97
  v_cvt_pk_bf16_f32 v129, v98, v99
  v_cvt_pk_bf16_f32 v130, v100, v101
  v_cvt_pk_bf16_f32 v131, v102, v103
  v_cvt_pk_bf16_f32 v132, v104, v105
  v_cvt_pk_bf16_f32 v133, v106, v107
  v_cvt_pk_bf16_f32 v134, v108, v109
  v_cvt_pk_bf16_f32 v135, v110, v111
  v_mfma_f32_16x16x32_bf16 v[144:147], v[128:131], v[16:19], 0
  s_nop 0
  v_mfma_f32_16x16x32_bf16 v[144:147], v[132:135], v[20:23], v[144:147]
  v_cndmask_b32 v234, v148, v149, s[40:41]
  v_cndmask_b32 v235, v150, v151, s[40:41]
  s_nop 0
  v_add_f32_dpp v234, v234, v234 row_ror:8 row_mask:0xf bank_mask:0xf
  v_add_f32_dpp v235, v235, v235 row_ror:8 row_mask:0xf bank_mask:0xf
  v_cvt_pk_bf16_f32 v26, v234, v235
  v_lshlrev_b32 v234, 16, v26
  v_and_b32 v235, 0xffff0000, v26
  v_mul_f32 v234, s45, v234
  v_mul_f32 v235, s45, v235
  v_cvt_pk_bf16_f32 v26, v234, v235
  v_lshlrev_b32 v234, 16, v26
  v_and_b32 v235, 0xffff0000, v26
  v_max3_f32 v24, v24, v234, v235
  s_waitcnt vmcnt(12)
  v_cvt_f32_i32 v112, v80
  v_cvt_f32_i32 v113, v81
  v_cvt_f32_i32 v114, v82
  v_cvt_f32_i32 v115, v83
  v_cvt_f32_i32 v116, v84
  v_cvt_f32_i32 v117, v85
  v_cvt_f32_i32 v118, v86
  v_cvt_f32_i32 v119, v87
  v_cvt_f32_i32 v120, v88
  v_cvt_f32_i32 v121, v89
  v_cvt_f32_i32 v122, v90
  v_cvt_f32_i32 v123, v91
  v_cvt_f32_i32 v124, v92
  v_cvt_f32_i32 v125, v93
  v_cvt_f32_i32 v126, v94
  v_cvt_f32_i32 v127, v95
  buffer_load_dwordx4 v[80:83], v1, s[24:27], s36 offen offset:0 nt
  buffer_load_dwordx4 v[84:87], v1, s[24:27], s36 offen offset:128 nt
  buffer_load_dwordx4 v[88:91], v1, s[24:27], s36 offen offset:256 nt
  buffer_load_dwordx4 v[92:95], v1, s[24:27], s36 offen offset:384 nt
  s_add_u32 s37, s37, 32768
  s_and_b32 s37, s37, 0x7ffff
  s_add_u32 s36, s69, s37
  v_pk_fma_f32 v[112:113], v[112:113], v[184:185], v[186:187]
  v_pk_fma_f32 v[114:115], v[114:115], v[188:189], v[190:191]
  v_pk_fma_f32 v[116:117], v[116:117], v[192:193], v[194:195]
  v_pk_fma_f32 v[118:119], v[118:119], v[196:197], v[198:199]
  v_pk_fma_f32 v[120:121], v[120:121], v[200:201], v[202:203]
  v_pk_fma_f32 v[122:123], v[122:123], v[204:205], v[206:207]
  v_pk_fma_f32 v[124:125], v[124:125], v[208:209], v[210:211]
  v_pk_fma_f32 v[126:127], v[126:127], v[212:213], v[214:215]
  v_cvt_pk_bf16_f32 v136, v112, v113
  v_cvt_pk_bf16_f32 v137, v114, v115
  v_cvt_pk_bf16_f32 v138, v116, v117
  v_cvt_pk_bf16_f32 v139, v118, v119
  v_cvt_pk_bf16_f32 v140, v120, v121
  v_cvt_pk_bf16_f32 v141, v122, v123
  v_cvt_pk_bf16_f32 v142, v124, v125
  v_cvt_pk_bf16_f32 v143, v126, v127
  v_mfma_f32_16x16x32_bf16 v[148:151], v[136:139], v[16:19], 0
  s_nop 0
  v_mfma_f32_16x16x32_bf16 v[148:151], v[140:143], v[20:23], v[148:151]
  v_cndmask_b32 v236, v144, v145, s[40:41]
  v_cndmask_b32 v237, v146, v147, s[40:41]
  s_nop 0
  v_add_f32_dpp v236, v236, v236 row_ror:8 row_mask:0xf bank_mask:0xf
  v_add_f32_dpp v237, v237, v237 row_ror:8 row_mask:0xf bank_mask:0xf
  v_cvt_pk_bf16_f32 v26, v236, v237
  v_lshlrev_b32 v236, 16, v26
  v_and_b32 v237, 0xffff0000, v26
  v_mul_f32 v236, s45, v236
  v_mul_f32 v237, s45, v237
  v_cvt_pk_bf16_f32 v26, v236, v237
  v_lshlrev_b32 v236, 16, v26
  v_and_b32 v237, 0xffff0000, v26
  v_max3_f32 v24, v24, v236, v237
  s_waitcnt vmcnt(12)
  v_cvt_f32_i32 v96, v32
  v_cvt_f32_i32 v97, v33
  v_cvt_f32_i32 v98, v34
  v_cvt_f32_i32 v99, v35
  v_cvt_f32_i32 v100, v36
  v_cvt_f32_i32 v101, v37
  v_cvt_f32_i32 v102, v38
  v_cvt_f32_i32 v103, v39
  v_cvt_f32_i32 v104, v40
  v_cvt_f32_i32 v105, v41
  v_cvt_f32_i32 v106, v42
  v_cvt_f32_i32 v107, v43
  v_cvt_f32_i32 v108, v44
  v_cvt_f32_i32 v109, v45
  v_cvt_f32_i32 v110, v46
  v_cvt_f32_i32 v111, v47
  buffer_load_dwordx4 v[32:35], v2, s[28:31], s36 offen offset:0 nt
  buffer_load_dwordx4 v[36:39], v2, s[28:31], s36 offen offset:256 nt
  buffer_load_dwordx4 v[40:43], v2, s[28:31], s36 offen offset:512 nt
  buffer_load_dwordx4 v[44:47], v2, s[28:31], s36 offen offset:768 nt
  s_add_u32 s37, s37, 32768
  s_and_b32 s37, s37, 0x7ffff
  s_add_u32 s36, s69, s37
  s_waitcnt lgkmcnt(0)
  v_pk_fma_f32 v[96:97], v[96:97], v[152:153], v[154:155]
  v_pk_fma_f32 v[98:99], v[98:99], v[156:157], v[158:159]
  v_pk_fma_f32 v[100:101], v[100:101], v[160:161], v[162:163]
  v_pk_fma_f32 v[102:103], v[102:103], v[164:165], v[166:167]
  v_pk_fma_f32 v[104:105], v[104:105], v[168:169], v[170:171]
  v_pk_fma_f32 v[106:107], v[106:107], v[172:173], v[174:175]
  v_pk_fma_f32 v[108:109], v[108:109], v[176:177], v[178:179]
  v_pk_fma_f32 v[110:111], v[110:111], v[180:181], v[182:183]
  s_lshr_b32 s46, s67, 6
  s_add_u32 s46, s46, 7168
  s_and_b32 s46, s46, 0x1fff
  v_add_u32 v5, s46, v3
  ds_read_b128 v[184:187], v5 offset:0
  ds_read_b128 v[188:191], v5 offset:16
  ds_read_b128 v[192:195], v5 offset:256
  ds_read_b128 v[196:199], v5 offset:272
  ds_read_b128 v[200:203], v5 offset:512
  ds_read_b128 v[204:207], v5 offset:528
  ds_read_b128 v[208:211], v5 offset:768
  ds_read_b128 v[212:215], v5 offset:784
  v_cvt_pk_bf16_f32 v128, v96, v97
  v_cvt_pk_bf16_f32 v129, v98, v99
  v_cvt_pk_bf16_f32 v130, v100, v101
  v_cvt_pk_bf16_f32 v131, v102, v103
  v_cvt_pk_bf16_f32 v132, v104, v105
  v_cvt_pk_bf16_f32 v133, v106, v107
  v_cvt_pk_bf16_f32 v134, v108, v109
  v_cvt_pk_bf16_f32 v135, v110, v111
  v_mfma_f32_16x16x32_bf16 v[144:147], v[128:131], v[16:19], 0
  s_nop 0
  v_mfma_f32_16x16x32_bf16 v[144:147], v[132:135], v[20:23], v[144:147]
  v_cndmask_b32 v238, v148, v149, s[40:41]
  v_cndmask_b32 v239, v150, v151, s[40:41]
  s_nop 0
  v_add_f32_dpp v238, v238, v238 row_ror:8 row_mask:0xf bank_mask:0xf
  v_add_f32_dpp v239, v239, v239 row_ror:8 row_mask:0xf bank_mask:0xf
  v_cvt_pk_bf16_f32 v26, v238, v239
  v_lshlrev_b32 v238, 16, v26
  v_and_b32 v239, 0xffff0000, v26
  v_mul_f32 v238, s45, v238
  v_mul_f32 v239, s45, v239
  v_cvt_pk_bf16_f32 v26, v238, v239
  v_lshlrev_b32 v238, 16, v26
  v_and_b32 v239, 0xffff0000, v26
  v_max3_f32 v24, v24, v238, v239
  s_waitcnt vmcnt(12)
  v_cvt_f32_i32 v112, v48
  v_cvt_f32_i32 v113, v49
  v_cvt_f32_i32 v114, v50
  v_cvt_f32_i32 v115, v51
  v_cvt_f32_i32 v116, v52
  v_cvt_f32_i32 v117, v53
  v_cvt_f32_i32 v118, v54
  v_cvt_f32_i32 v119, v55
  v_cvt_f32_i32 v120, v56
  v_cvt_f32_i32 v121, v57
  v_cvt_f32_i32 v122, v58
  v_cvt_f32_i32 v123, v59
  v_cvt_f32_i32 v124, v60
  v_cvt_f32_i32 v125, v61
  v_cvt_f32_i32 v126, v62
  v_cvt_f32_i32 v127, v63
  buffer_load_dwordx4 v[48:51], v2, s[28:31], s36 offen offset:0 nt
  buffer_load_dwordx4 v[52:55], v2, s[28:31], s36 offen offset:256 nt
  buffer_load_dwordx4 v[56:59], v2, s[28:31], s36 offen offset:512 nt
  buffer_load_dwordx4 v[60:63], v2, s[28:31], s36 offen offset:768 nt
  s_add_u32 s37, s37, 32768
  s_and_b32 s37, s37, 0x7ffff
  s_add_u32 s36, s69, s37
  v_pk_fma_f32 v[112:113], v[112:113], v[152:153], v[154:155]
  v_pk_fma_f32 v[114:115], v[114:115], v[156:157], v[158:159]
  v_pk_fma_f32 v[116:117], v[116:117], v[160:161], v[162:163]
  v_pk_fma_f32 v[118:119], v[118:119], v[164:165], v[166:167]
  v_pk_fma_f32 v[120:121], v[120:121], v[168:169], v[170:171]
  v_pk_fma_f32 v[122:123], v[122:123], v[172:173], v[174:175]
  v_pk_fma_f32 v[124:125], v[124:125], v[176:177], v[178:179]
  v_pk_fma_f32 v[126:127], v[126:127], v[180:181], v[182:183]
  v_cvt_pk_bf16_f32 v136, v112, v113
  v_cvt_pk_bf16_f32 v137, v114, v115
  v_cvt_pk_bf16_f32 v138, v116, v117
  v_cvt_pk_bf16_f32 v139, v118, v119
  v_cvt_pk_bf16_f32 v140, v120, v121
  v_cvt_pk_bf16_f32 v141, v122, v123
  v_cvt_pk_bf16_f32 v142, v124, v125
  v_cvt_pk_bf16_f32 v143, v126, v127
  v_mfma_f32_16x16x32_bf16 v[148:151], v[136:139], v[16:19], 0
  s_nop 0
  v_mfma_f32_16x16x32_bf16 v[148:151], v[140:143], v[20:23], v[148:151]
  v_cndmask_b32 v240, v144, v145, s[40:41]
  v_cndmask_b32 v241, v146, v147, s[40:41]
  s_nop 0
  v_add_f32_dpp v240, v240, v240 row_ror:8 row_mask:0xf bank_mask:0xf
  v_add_f32_dpp v241, v241, v241 row_ror:8 row_mask:0xf bank_mask:0xf
  v_cvt_pk_bf16_f32 v26, v240, v241
  v_lshlrev_b32 v240, 16, v26
  v_and_b32 v241, 0xffff0000, v26
  v_mul_f32 v240, s45, v240
  v_mul_f32 v241, s45, v241
  v_cvt_pk_bf16_f32 v26, v240, v241
  v_lshlrev_b32 v240, 16, v26
  v_and_b32 v241, 0xffff0000, v26
  v_max3_f32 v24, v24, v240, v241
  s_waitcnt vmcnt(12)
  v_cvt_f32_i32 v96, v64
  v_cvt_f32_i32 v97, v65
  v_cvt_f32_i32 v98, v66
  v_cvt_f32_i32 v99, v67
  v_cvt_f32_i32 v100, v68
  v_cvt_f32_i32 v101, v69
  v_cvt_f32_i32 v102, v70
  v_cvt_f32_i32 v103, v71
  v_cvt_f32_i32 v104, v72
  v_cvt_f32_i32 v105, v73
  v_cvt_f32_i32 v106, v74
  v_cvt_f32_i32 v107, v75
  v_cvt_f32_i32 v108, v76
  v_cvt_f32_i32 v109, v77
  v_cvt_f32_i32 v110, v78
  v_cvt_f32_i32 v111, v79
  buffer_load_dwordx4 v[64:67], v2, s[28:31], s36 offen offset:0 nt
  buffer_load_dwordx4 v[68:71], v2, s[28:31], s36 offen offset:256 nt
  buffer_load_dwordx4 v[72:75], v2, s[28:31], s36 offen offset:512 nt
  buffer_load_dwordx4 v[76:79], v2, s[28:31], s36 offen offset:768 nt
  s_add_u32 s37, s37, 32768
  s_and_b32 s37, s37, 0x7ffff
  s_add_u32 s36, s69, s37
  s_waitcnt lgkmcnt(0)
  v_pk_fma_f32 v[96:97], v[96:97], v[184:185], v[186:187]
  v_pk_fma_f32 v[98:99], v[98:99], v[188:189], v[190:191]
  v_pk_fma_f32 v[100:101], v[100:101], v[192:193], v[194:195]
  v_pk_fma_f32 v[102:103], v[102:103], v[196:197], v[198:199]
  v_pk_fma_f32 v[104:105], v[104:105], v[200:201], v[202:203]
  v_pk_fma_f32 v[106:107], v[106:107], v[204:205], v[206:207]
  v_pk_fma_f32 v[108:109], v[108:109], v[208:209], v[210:211]
  v_pk_fma_f32 v[110:111], v[110:111], v[212:213], v[214:215]
  v_cvt_pk_bf16_f32 v128, v96, v97
  v_cvt_pk_bf16_f32 v129, v98, v99
  v_cvt_pk_bf16_f32 v130, v100, v101
  v_cvt_pk_bf16_f32 v131, v102, v103
  v_cvt_pk_bf16_f32 v132, v104, v105
  v_cvt_pk_bf16_f32 v133, v106, v107
  v_cvt_pk_bf16_f32 v134, v108, v109
  v_cvt_pk_bf16_f32 v135, v110, v111
  v_mfma_f32_16x16x32_bf16 v[144:147], v[128:131], v[16:19], 0
  s_nop 0
  v_mfma_f32_16x16x32_bf16 v[144:147], v[132:135], v[20:23], v[144:147]
  v_cndmask_b32 v242, v148, v149, s[40:41]
  v_cndmask_b32 v243, v150, v151, s[40:41]
  s_nop 0
  v_add_f32_dpp v242, v242, v242 row_ror:8 row_mask:0xf bank_mask:0xf
  v_add_f32_dpp v243, v243, v243 row_ror:8 row_mask:0xf bank_mask:0xf
  v_cvt_pk_bf16_f32 v26, v242, v243
  v_lshlrev_b32 v242, 16, v26
  v_and_b32 v243, 0xffff0000, v26
  v_mul_f32 v242, s45, v242
  v_mul_f32 v243, s45, v243
  v_cvt_pk_bf16_f32 v26, v242, v243
  v_lshlrev_b32 v242, 16, v26
  v_and_b32 v243, 0xffff0000, v26
  v_max3_f32 v24, v24, v242, v243
  s_waitcnt vmcnt(12)
  v_cvt_f32_i32 v112, v80
  v_cvt_f32_i32 v113, v81
  v_cvt_f32_i32 v114, v82
  v_cvt_f32_i32 v115, v83
  v_cvt_f32_i32 v116, v84
  v_cvt_f32_i32 v117, v85
  v_cvt_f32_i32 v118, v86
  v_cvt_f32_i32 v119, v87
  v_cvt_f32_i32 v120, v88
  v_cvt_f32_i32 v121, v89
  v_cvt_f32_i32 v122, v90
  v_cvt_f32_i32 v123, v91
  v_cvt_f32_i32 v124, v92
  v_cvt_f32_i32 v125, v93
  v_cvt_f32_i32 v126, v94
  v_cvt_f32_i32 v127, v95
  buffer_load_dwordx4 v[80:83], v2, s[28:31], s36 offen offset:0 nt
  buffer_load_dwordx4 v[84:87], v2, s[28:31], s36 offen offset:256 nt
  buffer_load_dwordx4 v[88:91], v2, s[28:31], s36 offen offset:512 nt
  buffer_load_dwordx4 v[92:95], v2, s[28:31], s36 offen offset:768 nt
  s_add_u32 s37, s37, 32768
  s_and_b32 s37, s37, 0x7ffff
  s_add_u32 s36, s69, s37
  v_pk_fma_f32 v[112:113], v[112:113], v[184:185], v[186:187]
  v_pk_fma_f32 v[114:115], v[114:115], v[188:189], v[190:191]
  v_pk_fma_f32 v[116:117], v[116:117], v[192:193], v[194:195]
  v_pk_fma_f32 v[118:119], v[118:119], v[196:197], v[198:199]
  v_pk_fma_f32 v[120:121], v[120:121], v[200:201], v[202:203]
  v_pk_fma_f32 v[122:123], v[122:123], v[204:205], v[206:207]
  v_pk_fma_f32 v[124:125], v[124:125], v[208:209], v[210:211]
  v_pk_fma_f32 v[126:127], v[126:127], v[212:213], v[214:215]
  v_cvt_pk_bf16_f32 v136, v112, v113
  v_cvt_pk_bf16_f32 v137, v114, v115
  v_cvt_pk_bf16_f32 v138, v116, v117
  v_cvt_pk_bf16_f32 v139, v118, v119
  v_cvt_pk_bf16_f32 v140, v120, v121
  v_cvt_pk_bf16_f32 v141, v122, v123
  v_cvt_pk_bf16_f32 v142, v124, v125
  v_cvt_pk_bf16_f32 v143, v126, v127
  v_mfma_f32_16x16x32_bf16 v[148:151], v[136:139], v[16:19], 0
  s_nop 0
  v_mfma_f32_16x16x32_bf16 v[148:151], v[140:143], v[20:23], v[148:151]
  v_cndmask_b32 v244, v144, v145, s[40:41]
  v_cndmask_b32 v245, v146, v147, s[40:41]
  s_nop 0
  v_add_f32_dpp v244, v244, v244 row_ror:8 row_mask:0xf bank_mask:0xf
  v_add_f32_dpp v245, v245, v245 row_ror:8 row_mask:0xf bank_mask:0xf
  v_cvt_pk_bf16_f32 v26, v244, v245
  v_lshlrev_b32 v244, 16, v26
  v_and_b32 v245, 0xffff0000, v26
  v_mul_f32 v244, s45, v244
  v_mul_f32 v245, s45, v245
  v_cvt_pk_bf16_f32 v26, v244, v245
  v_lshlrev_b32 v244, 16, v26
  v_and_b32 v245, 0xffff0000, v26
  v_max3_f32 v24, v24, v244, v245
  v_cndmask_b32 v246, v148, v149, s[40:41]
  v_cndmask_b32 v247, v150, v151, s[40:41]
  s_nop 0
  v_add_f32_dpp v246, v246, v246 row_ror:8 row_mask:0xf bank_mask:0xf
  v_add_f32_dpp v247, v247, v247 row_ror:8 row_mask:0xf bank_mask:0xf
  v_cvt_pk_bf16_f32 v26, v246, v247
  v_lshlrev_b32 v246, 16, v26
  v_and_b32 v247, 0xffff0000, v26
  v_mul_f32 v246, s45, v246
  v_mul_f32 v247, s45, v247
  v_cvt_pk_bf16_f32 v26, v246, v247
  v_lshlrev_b32 v246, 16, v26
  v_and_b32 v247, 0xffff0000, v26
  v_max3_f32 v24, v24, v246, v247
  s_lshr_b32 s46, s67, 6
  s_add_u32 s46, s46, 0
  s_and_b32 s46, s46, 0x1fff
  v_add_u32 v1, s46, v4
  ds_read_b128 v[8:11], v1 offset:8192
  v_mov_b32 v26, v24
  s_nop 1
  v_permlane32_swap_b32 v24, v26
  v_max_f32 v24, v24, v26
  v_mov_b32 v26, v24
  s_nop 1
  v_permlane16_swap_b32 v24, v26
  v_max_f32 v24, v24, v26
  v_mul_f32 v27, s44, v24
  v_sub_f32 v27, 0, v27
  v_fma_f32 v216, v216, s44, v27
  v_fma_f32 v217, v217, s44, v27
  v_fma_f32 v218, v218, s44, v27
  v_fma_f32 v219, v219, s44, v27
  v_fma_f32 v220, v220, s44, v27
  v_fma_f32 v221, v221, s44, v27
  v_fma_f32 v222, v222, s44, v27
  v_fma_f32 v223, v223, s44, v27
  v_fma_f32 v224, v224, s44, v27
  v_fma_f32 v225, v225, s44, v27
  v_fma_f32 v226, v226, s44, v27
  v_fma_f32 v227, v227, s44, v27
  v_fma_f32 v228, v228, s44, v27
  v_fma_f32 v229, v229, s44, v27
  v_fma_f32 v230, v230, s44, v27
  v_fma_f32 v231, v231, s44, v27
  v_fma_f32 v232, v232, s44, v27
  v_fma_f32 v233, v233, s44, v27
  v_fma_f32 v234, v234, s44, v27
  v_fma_f32 v235, v235, s44, v27
  v_fma_f32 v236, v236, s44, v27
  v_fma_f32 v237, v237, s44, v27
  v_fma_f32 v238, v238, s44, v27
  v_fma_f32 v239, v239, s44, v27
  v_fma_f32 v240, v240, s44, v27
  v_fma_f32 v241, v241, s44, v27
  v_fma_f32 v242, v242, s44, v27
  v_fma_f32 v243, v243, s44, v27
  v_fma_f32 v244, v244, s44, v27
  v_fma_f32 v245, v245, s44, v27
  v_fma_f32 v246, v246, s44, v27
  v_fma_f32 v247, v247, s44, v27
  v_exp_f32 v216, v216
  v_exp_f32 v217, v217
  v_exp_f32 v218, v218
  v_exp_f32 v219, v219
  v_exp_f32 v220, v220
  v_exp_f32 v221, v221
  v_exp_f32 v222, v222
  v_exp_f32 v223, v223
  v_exp_f32 v224, v224
  v_exp_f32 v225, v225
  v_exp_f32 v226, v226
  v_exp_f32 v227, v227
  v_exp_f32 v228, v228
  v_exp_f32 v229, v229
  v_exp_f32 v230, v230
  v_exp_f32 v231, v231
  v_exp_f32 v232, v232
  v_exp_f32 v233, v233
  v_exp_f32 v234, v234
  v_exp_f32 v235, v235
  v_exp_f32 v236, v236
  v_exp_f32 v237, v237
  v_exp_f32 v238, v238
  v_exp_f32 v239, v239
  v_exp_f32 v240, v240
  v_exp_f32 v241, v241
  v_exp_f32 v242, v242
  v_exp_f32 v243, v243
  v_exp_f32 v244, v244
  v_exp_f32 v245, v245
  v_exp_f32 v246, v246
  v_exp_f32 v247, v247
  v_cvt_pk_bf16_f32 v128, v216, v217
  v_cvt_pk_bf16_f32 v129, v218, v219
  v_cvt_pk_bf16_f32 v130, v220, v221
  v_cvt_pk_bf16_f32 v131, v222, v223
  v_cvt_pk_bf16_f32 v132, v224, v225
  v_cvt_pk_bf16_f32 v133, v226, v227
  v_cvt_pk_bf16_f32 v134, v228, v229
  v_cvt_pk_bf16_f32 v135, v230, v231
  v_cvt_pk_bf16_f32 v136, v232, v233
  v_cvt_pk_bf16_f32 v137, v234, v235
  v_cvt_pk_bf16_f32 v138, v236, v237
  v_cvt_pk_bf16_f32 v139, v238, v239
  v_cvt_pk_bf16_f32 v140, v240, v241
  v_cvt_pk_bf16_f32 v141, v242, v243
  v_cvt_pk_bf16_f32 v142, v244, v245
  v_cvt_pk_bf16_f32 v143, v246, v247
  v_add_f32 v25, v216, v217
  v_add_f32 v28, v218, v219
  v_add_f32 v25, v25, v220
  v_add_f32 v28, v28, v221
  v_add_f32 v25, v25, v222
  v_add_f32 v28, v28, v223
  v_add_f32 v25, v25, v224
  v_add_f32 v28, v28, v225
  v_add_f32 v25, v25, v226
  v_add_f32 v28, v28, v227
  v_add_f32 v25, v25, v228
  v_add_f32 v28, v28, v229
  v_add_f32 v25, v25, v230
  v_add_f32 v28, v28, v231
  v_add_f32 v25, v25, v232
  v_add_f32 v28, v28, v233
  v_add_f32 v25, v25, v234
  v_add_f32 v28, v28, v235
  v_add_f32 v25, v25, v236
  v_add_f32 v28, v28, v237
  v_add_f32 v25, v25, v238
  v_add_f32 v28, v28, v239
  v_add_f32 v25, v25, v240
  v_add_f32 v28, v28, v241
  v_add_f32 v25, v25, v242
  v_add_f32 v28, v28, v243
  v_add_f32 v25, v25, v244
  v_add_f32 v28, v28, v245
  v_add_f32 v25, v25, v246
  v_add_f32 v28, v28, v247
  v_add_f32 v25, v25, v28
  v_mov_b32 v26, v25
  s_nop 1
  v_permlane32_swap_b32 v25, v26
  v_add_f32 v25, v25, v26
  v_mov_b32 v26, v25
  s_nop 1
  v_permlane16_swap_b32 v25, v26
  v_add_f32 v25, v25, v26
  v_and_b32 v28, 7, v0
  v_lshlrev_b32 v28, 6, v28
  s_lshl_b32 s38, s3, 3
  v_add_u32 v28, s38, v28
  ds_write_b64 v28, v[24:25] offset:51200
  v_mov_b32 v3, 51712
  v_mov_b32 v24, 1
  s_mov_b64 exec, 1
  ds_add_u32 v3, v24 offset:16
  s_mov_b64 exec, -1
  v_lshrrev_b32 v26, 4, v0
  v_and_b32 v5, 1, v26
  v_lshlrev_b32 v5, 11, v5
  v_lshrrev_b32 v26, 1, v26
  v_lshl_add_u32 v5, v26, 8, v5
  v_and_b32 v26, 15, v0
  v_lshl_add_u32 v5, v26, 4, v5
  s_lshl_b32 s38, s3, 12
  v_add_u32 v5, s38, v5
  s_lshl_b32 s38, s3, 9
  v_lshlrev_b32 v6, 3, v0
  v_add_u32 v6, s38, v6
  v_lshlrev_b32 v30, 4, v0
  s_lshl_b32 s38, s3, 10
  v_add_u32 v7, s38, v30
  v_lshlrev_b32 v31, 2, v0
  s_lshl_b32 s64, s2, 13
  s_add_u32 s64, s64, s38
  s_lshr_b32 s46, s2, 1
  s_lshl_b32 s65, s46, 11
  s_lshl_b32 s38, s3, 8
  s_add_u32 s65, s65, s38
  s_and_b32 s47, s46, 1
  s_lshl_b32 s47, s47, 4
  s_lshr_b32 s46, s46, 1
  s_lshl_b32 s70, s46, 2
  s_mov_b32 s32, s22
  s_mov_b32 s33, s23
  s_mov_b32 s34, 0x200000
  s_mov_b32 s35, 0x20000
  s_mov_b32 s56, s18
  s_mov_b32 s57, s19
  s_mov_b32 s58, 0x40000
  s_mov_b32 s59, 0x20000
  s_lshl_b32 s38, s3, 6
  v_mov_b32 v25, s38
  s_mov_b32 s66, 0
  s_waitcnt vmcnt(12)
  v_cvt_f32_i32 v96, v32
  v_cvt_f32_i32 v97, v33
  v_cvt_f32_i32 v98, v34
  v_cvt_f32_i32 v99, v35
  v_cvt_f32_i32 v100, v36
  v_cvt_f32_i32 v101, v37
  v_cvt_f32_i32 v102, v38
  v_cvt_f32_i32 v103, v39
  v_cvt_f32_i32 v104, v40
  v_cvt_f32_i32 v105, v41
  v_cvt_f32_i32 v106, v42
  v_cvt_f32_i32 v107, v43
  v_cvt_f32_i32 v108, v44
  v_cvt_f32_i32 v109, v45
  v_cvt_f32_i32 v110, v46
  v_cvt_f32_i32 v111, v47
  buffer_load_dwordx4 v[32:35], v2, s[28:31], s36 offen offset:0 nt
  buffer_load_dwordx4 v[36:39], v2, s[28:31], s36 offen offset:256 nt
  buffer_load_dwordx4 v[40:43], v2, s[28:31], s36 offen offset:512 nt
  buffer_load_dwordx4 v[44:47], v2, s[28:31], s36 offen offset:768 nt
  s_add_u32 s37, s37, 32768
  s_and_b32 s37, s37, 0x7ffff
  s_add_u32 s36, s69, s37
  s_waitcnt lgkmcnt(0)
  s_lshr_b32 s46, s67, 6
  s_add_u32 s46, s46, 512
  s_and_b32 s46, s46, 0x1fff
  v_add_u32 v1, s46, v4
  ds_read_b128 v[12:15], v1 offset:8192
  v_pk_fma_f32 v[96:97], v[96:97], v[8:9], v[10:11] op_sel:[0,0,0] op_sel_hi:[1,0,0]
  v_pk_fma_f32 v[98:99], v[98:99], v[8:9], v[10:11] op_sel:[0,0,0] op_sel_hi:[1,0,0]
  v_pk_fma_f32 v[100:101], v[100:101], v[8:9], v[10:11] op_sel:[0,0,0] op_sel_hi:[1,0,0]
  v_pk_fma_f32 v[102:103], v[102:103], v[8:9], v[10:11] op_sel:[0,0,0] op_sel_hi:[1,0,0]
  v_pk_fma_f32 v[104:105], v[104:105], v[8:9], v[10:11] op_sel:[0,1,1] op_sel_hi:[1,1,1]
  v_pk_fma_f32 v[106:107], v[106:107], v[8:9], v[10:11] op_sel:[0,1,1] op_sel_hi:[1,1,1]
  v_pk_fma_f32 v[108:109], v[108:109], v[8:9], v[10:11] op_sel:[0,1,1] op_sel_hi:[1,1,1]
  v_pk_fma_f32 v[110:111], v[110:111], v[8:9], v[10:11] op_sel:[0,1,1] op_sel_hi:[1,1,1]
  v_cvt_pk_bf16_f32 v152, v96, v104
  v_cvt_pk_bf16_f32 v156, v97, v105
  v_cvt_pk_bf16_f32 v160, v98, v106
  v_cvt_pk_bf16_f32 v164, v99, v107
  v_cvt_pk_bf16_f32 v168, v100, v108
  v_cvt_pk_bf16_f32 v172, v101, v109
  v_cvt_pk_bf16_f32 v176, v102, v110
  v_cvt_pk_bf16_f32 v180, v103, v111
  s_waitcnt vmcnt(12)
  v_cvt_f32_i32 v112, v48
  v_cvt_f32_i32 v113, v49
  v_cvt_f32_i32 v114, v50
  v_cvt_f32_i32 v115, v51
  v_cvt_f32_i32 v116, v52
  v_cvt_f32_i32 v117, v53
  v_cvt_f32_i32 v118, v54
  v_cvt_f32_i32 v119, v55
  v_cvt_f32_i32 v120, v56
  v_cvt_f32_i32 v121, v57
  v_cvt_f32_i32 v122, v58
  v_cvt_f32_i32 v123, v59
  v_cvt_f32_i32 v124, v60
  v_cvt_f32_i32 v125, v61
  v_cvt_f32_i32 v126, v62
  v_cvt_f32_i32 v127, v63
  buffer_load_dwordx4 v[48:51], v2, s[28:31], s36 offen offset:0 nt
  buffer_load_dwordx4 v[52:55], v2, s[28:31], s36 offen offset:256 nt
  buffer_load_dwordx4 v[56:59], v2, s[28:31], s36 offen offset:512 nt
  buffer_load_dwordx4 v[60:63], v2, s[28:31], s36 offen offset:768 nt
  s_add_u32 s37, s37, 32768
  s_and_b32 s37, s37, 0x7ffff
  s_add_u32 s36, s69, s37
  s_waitcnt lgkmcnt(0)
  s_lshr_b32 s46, s67, 6
  s_add_u32 s46, s46, 1024
  s_and_b32 s46, s46, 0x1fff
  v_add_u32 v1, s46, v4
  ds_read_b128 v[8:11], v1 offset:8192
  v_pk_fma_f32 v[112:113], v[112:113], v[12:13], v[14:15] op_sel:[0,0,0] op_sel_hi:[1,0,0]
  v_pk_fma_f32 v[114:115], v[114:115], v[12:13], v[14:15] op_sel:[0,0,0] op_sel_hi:[1,0,0]
  v_pk_fma_f32 v[116:117], v[116:117], v[12:13], v[14:15] op_sel:[0,0,0] op_sel_hi:[1,0,0]
  v_pk_fma_f32 v[118:119], v[118:119], v[12:13], v[14:15] op_sel:[0,0,0] op_sel_hi:[1,0,0]
  v_pk_fma_f32 v[120:121], v[120:121], v[12:13], v[14:15] op_sel:[0,1,1] op_sel_hi:[1,1,1]
  v_pk_fma_f32 v[122:123], v[122:123], v[12:13], v[14:15] op_sel:[0,1,1] op_sel_hi:[1,1,1]
  v_pk_fma_f32 v[124:125], v[124:125], v[12:13], v[14:15] op_sel:[0,1,1] op_sel_hi:[1,1,1]
  v_pk_fma_f32 v[126:127], v[126:127], v[12:13], v[14:15] op_sel:[0,1,1] op_sel_hi:[1,1,1]
  v_cvt_pk_bf16_f32 v153, v112, v120
  v_cvt_pk_bf16_f32 v157, v113, v121
  v_cvt_pk_bf16_f32 v161, v114, v122
  v_cvt_pk_bf16_f32 v165, v115, v123
  v_cvt_pk_bf16_f32 v169, v116, v124
  v_cvt_pk_bf16_f32 v173, v117, v125
  v_cvt_pk_bf16_f32 v177, v118, v126
  v_cvt_pk_bf16_f32 v181, v119, v127
  s_waitcnt vmcnt(12)
  v_cvt_f32_i32 v96, v64
  v_cvt_f32_i32 v97, v65
  v_cvt_f32_i32 v98, v66
  v_cvt_f32_i32 v99, v67
  v_cvt_f32_i32 v100, v68
  v_cvt_f32_i32 v101, v69
  v_cvt_f32_i32 v102, v70
  v_cvt_f32_i32 v103, v71
  v_cvt_f32_i32 v104, v72
  v_cvt_f32_i32 v105, v73
  v_cvt_f32_i32 v106, v74
  v_cvt_f32_i32 v107, v75
  v_cvt_f32_i32 v108, v76
  v_cvt_f32_i32 v109, v77
  v_cvt_f32_i32 v110, v78
  v_cvt_f32_i32 v111, v79
  buffer_load_dwordx4 v[64:67], v2, s[28:31], s36 offen offset:0 nt
  buffer_load_dwordx4 v[68:71], v2, s[28:31], s36 offen offset:256 nt
  buffer_load_dwordx4 v[72:75], v2, s[28:31], s36 offen offset:512 nt
  buffer_load_dwordx4 v[76:79], v2, s[28:31], s36 offen offset:768 nt
  s_add_u32 s37, s37, 32768
  s_and_b32 s37, s37, 0x7ffff
  s_add_u32 s36, s69, s37
  s_waitcnt lgkmcnt(0)
  s_lshr_b32 s46, s67, 6
  s_add_u32 s46, s46, 1536
  s_and_b32 s46, s46, 0x1fff
  v_add_u32 v1, s46, v4
  ds_read_b128 v[12:15], v1 offset:8192
  v_pk_fma_f32 v[96:97], v[96:97], v[8:9], v[10:11] op_sel:[0,0,0] op_sel_hi:[1,0,0]
  v_pk_fma_f32 v[98:99], v[98:99], v[8:9], v[10:11] op_sel:[0,0,0] op_sel_hi:[1,0,0]
  v_pk_fma_f32 v[100:101], v[100:101], v[8:9], v[10:11] op_sel:[0,0,0] op_sel_hi:[1,0,0]
  v_pk_fma_f32 v[102:103], v[102:103], v[8:9], v[10:11] op_sel:[0,0,0] op_sel_hi:[1,0,0]
  v_pk_fma_f32 v[104:105], v[104:105], v[8:9], v[10:11] op_sel:[0,1,1] op_sel_hi:[1,1,1]
  v_pk_fma_f32 v[106:107], v[106:107], v[8:9], v[10:11] op_sel:[0,1,1] op_sel_hi:[1,1,1]
  v_pk_fma_f32 v[108:109], v[108:109], v[8:9], v[10:11] op_sel:[0,1,1] op_sel_hi:[1,1,1]
  v_pk_fma_f32 v[110:111], v[110:111], v[8:9], v[10:11] op_sel:[0,1,1] op_sel_hi:[1,1,1]
  v_cvt_pk_bf16_f32 v154, v96, v104
  v_cvt_pk_bf16_f32 v158, v97, v105
  v_cvt_pk_bf16_f32 v162, v98, v106
  v_cvt_pk_bf16_f32 v166, v99, v107
  v_cvt_pk_bf16_f32 v170, v100, v108
  v_cvt_pk_bf16_f32 v174, v101, v109
  v_cvt_pk_bf16_f32 v178, v102, v110
  v_cvt_pk_bf16_f32 v182, v103, v111
  s_waitcnt vmcnt(12)
  v_cvt_f32_i32 v112, v80
  v_cvt_f32_i32 v113, v81
  v_cvt_f32_i32 v114, v82
  v_cvt_f32_i32 v115, v83
  v_cvt_f32_i32 v116, v84
  v_cvt_f32_i32 v117, v85
  v_cvt_f32_i32 v118, v86
  v_cvt_f32_i32 v119, v87
  v_cvt_f32_i32 v120, v88
  v_cvt_f32_i32 v121, v89
  v_cvt_f32_i32 v122, v90
  v_cvt_f32_i32 v123, v91
  v_cvt_f32_i32 v124, v92
  v_cvt_f32_i32 v125, v93
  v_cvt_f32_i32 v126, v94
  v_cvt_f32_i32 v127, v95
  buffer_load_dwordx4 v[80:83], v2, s[28:31], s36 offen offset:0 nt
  buffer_load_dwordx4 v[84:87], v2, s[28:31], s36 offen offset:256 nt
  buffer_load_dwordx4 v[88:91], v2, s[28:31], s36 offen offset:512 nt
  buffer_load_dwordx4 v[92:95], v2, s[28:31], s36 offen offset:768 nt
  s_add_u32 s37, s37, 32768
  s_and_b32 s37, s37, 0x7ffff
  s_add_u32 s36, s69, s37
  s_waitcnt lgkmcnt(0)
  s_lshr_b32 s46, s67, 6
  s_add_u32 s46, s46, 2048
  s_and_b32 s46, s46, 0x1fff
  v_add_u32 v1, s46, v4
  ds_read_b128 v[8:11], v1 offset:8192
  v_pk_fma_f32 v[112:113], v[112:113], v[12:13], v[14:15] op_sel:[0,0,0] op_sel_hi:[1,0,0]
  v_pk_fma_f32 v[114:115], v[114:115], v[12:13], v[14:15] op_sel:[0,0,0] op_sel_hi:[1,0,0]
  v_pk_fma_f32 v[116:117], v[116:117], v[12:13], v[14:15] op_sel:[0,0,0] op_sel_hi:[1,0,0]
  v_pk_fma_f32 v[118:119], v[118:119], v[12:13], v[14:15] op_sel:[0,0,0] op_sel_hi:[1,0,0]
  v_pk_fma_f32 v[120:121], v[120:121], v[12:13], v[14:15] op_sel:[0,1,1] op_sel_hi:[1,1,1]
  v_pk_fma_f32 v[122:123], v[122:123], v[12:13], v[14:15] op_sel:[0,1,1] op_sel_hi:[1,1,1]
  v_pk_fma_f32 v[124:125], v[124:125], v[12:13], v[14:15] op_sel:[0,1,1] op_sel_hi:[1,1,1]
  v_pk_fma_f32 v[126:127], v[126:127], v[12:13], v[14:15] op_sel:[0,1,1] op_sel_hi:[1,1,1]
  v_cvt_pk_bf16_f32 v155, v112, v120
  v_cvt_pk_bf16_f32 v159, v113, v121
  v_cvt_pk_bf16_f32 v163, v114, v122
  v_cvt_pk_bf16_f32 v167, v115, v123
  v_cvt_pk_bf16_f32 v171, v116, v124
  v_cvt_pk_bf16_f32 v175, v117, v125
  v_cvt_pk_bf16_f32 v179, v118, v126
  v_cvt_pk_bf16_f32 v183, v119, v127
  v_mfma_f32_16x16x32_bf16 v[184:187], v[128:131], v[152:155], 0
  v_mfma_f32_16x16x32_bf16 v[188:191], v[128:131], v[156:159], 0
  v_mfma_f32_16x16x32_bf16 v[192:195], v[128:131], v[160:163], 0
  v_mfma_f32_16x16x32_bf16 v[196:199], v[128:131], v[164:167], 0
  v_mfma_f32_16x16x32_bf16 v[200:203], v[128:131], v[168:171], 0
  v_mfma_f32_16x16x32_bf16 v[204:207], v[128:131], v[172:175], 0
  v_mfma_f32_16x16x32_bf16 v[208:211], v[128:131], v[176:179], 0
  v_mfma_f32_16x16x32_bf16 v[212:215], v[128:131], v[180:183], 0
  s_waitcnt vmcnt(12)
  v_cvt_f32_i32 v96, v32
  v_cvt_f32_i32 v97, v33
  v_cvt_f32_i32 v98, v34
  v_cvt_f32_i32 v99, v35
  v_cvt_f32_i32 v100, v36
  v_cvt_f32_i32 v101, v37
  v_cvt_f32_i32 v102, v38
  v_cvt_f32_i32 v103, v39
  v_cvt_f32_i32 v104, v40
  v_cvt_f32_i32 v105, v41
  v_cvt_f32_i32 v106, v42
  v_cvt_f32_i32 v107, v43
  v_cvt_f32_i32 v108, v44
  v_cvt_f32_i32 v109, v45
  v_cvt_f32_i32 v110, v46
  v_cvt_f32_i32 v111, v47
  buffer_load_dwordx4 v[32:35], v2, s[28:31], s36 offen offset:0 nt
  buffer_load_dwordx4 v[36:39], v2, s[28:31], s36 offen offset:256 nt
  buffer_load_dwordx4 v[40:43], v2, s[28:31], s36 offen offset:512 nt
  buffer_load_dwordx4 v[44:47], v2, s[28:31], s36 offen offset:768 nt
  s_add_u32 s37, s37, 32768
  s_and_b32 s37, s37, 0x7ffff
  s_add_u32 s36, s69, s37
  s_waitcnt lgkmcnt(0)
  s_lshr_b32 s46, s67, 6
  s_add_u32 s46, s46, 2560
  s_and_b32 s46, s46, 0x1fff
  v_add_u32 v1, s46, v4
  ds_read_b128 v[12:15], v1 offset:8192
  v_pk_fma_f32 v[96:97], v[96:97], v[8:9], v[10:11] op_sel:[0,0,0] op_sel_hi:[1,0,0]
  v_pk_fma_f32 v[98:99], v[98:99], v[8:9], v[10:11] op_sel:[0,0,0] op_sel_hi:[1,0,0]
  v_pk_fma_f32 v[100:101], v[100:101], v[8:9], v[10:11] op_sel:[0,0,0] op_sel_hi:[1,0,0]
  v_pk_fma_f32 v[102:103], v[102:103], v[8:9], v[10:11] op_sel:[0,0,0] op_sel_hi:[1,0,0]
  v_pk_fma_f32 v[104:105], v[104:105], v[8:9], v[10:11] op_sel:[0,1,1] op_sel_hi:[1,1,1]
  v_pk_fma_f32 v[106:107], v[106:107], v[8:9], v[10:11] op_sel:[0,1,1] op_sel_hi:[1,1,1]
  v_pk_fma_f32 v[108:109], v[108:109], v[8:9], v[10:11] op_sel:[0,1,1] op_sel_hi:[1,1,1]
  v_pk_fma_f32 v[110:111], v[110:111], v[8:9], v[10:11] op_sel:[0,1,1] op_sel_hi:[1,1,1]
  v_cvt_pk_bf16_f32 v152, v96, v104
  v_cvt_pk_bf16_f32 v156, v97, v105
  v_cvt_pk_bf16_f32 v160, v98, v106
  v_cvt_pk_bf16_f32 v164, v99, v107
  v_cvt_pk_bf16_f32 v168, v100, v108
  v_cvt_pk_bf16_f32 v172, v101, v109
  v_cvt_pk_bf16_f32 v176, v102, v110
  v_cvt_pk_bf16_f32 v180, v103, v111
  s_waitcnt vmcnt(12)
  v_cvt_f32_i32 v112, v48
  v_cvt_f32_i32 v113, v49
  v_cvt_f32_i32 v114, v50
  v_cvt_f32_i32 v115, v51
  v_cvt_f32_i32 v116, v52
  v_cvt_f32_i32 v117, v53
  v_cvt_f32_i32 v118, v54
  v_cvt_f32_i32 v119, v55
  v_cvt_f32_i32 v120, v56
  v_cvt_f32_i32 v121, v57
  v_cvt_f32_i32 v122, v58
  v_cvt_f32_i32 v123, v59
  v_cvt_f32_i32 v124, v60
  v_cvt_f32_i32 v125, v61
  v_cvt_f32_i32 v126, v62
  v_cvt_f32_i32 v127, v63
  buffer_load_dwordx4 v[48:51], v2, s[28:31], s36 offen offset:0 nt
  buffer_load_dwordx4 v[52:55], v2, s[28:31], s36 offen offset:256 nt
  buffer_load_dwordx4 v[56:59], v2, s[28:31], s36 offen offset:512 nt
  buffer_load_dwordx4 v[60:63], v2, s[28:31], s36 offen offset:768 nt
  s_add_u32 s37, s37, 32768
  s_and_b32 s37, s37, 0x7ffff
  s_add_u32 s36, s69, s37
  s_waitcnt lgkmcnt(0)
  s_lshr_b32 s46, s67, 6
  s_add_u32 s46, s46, 3072
  s_and_b32 s46, s46, 0x1fff
  v_add_u32 v1, s46, v4
  ds_read_b128 v[8:11], v1 offset:8192
  v_pk_fma_f32 v[112:113], v[112:113], v[12:13], v[14:15] op_sel:[0,0,0] op_sel_hi:[1,0,0]
  v_pk_fma_f32 v[114:115], v[114:115], v[12:13], v[14:15] op_sel:[0,0,0] op_sel_hi:[1,0,0]
  v_pk_fma_f32 v[116:117], v[116:117], v[12:13], v[14:15] op_sel:[0,0,0] op_sel_hi:[1,0,0]
  v_pk_fma_f32 v[118:119], v[118:119], v[12:13], v[14:15] op_sel:[0,0,0] op_sel_hi:[1,0,0]
  v_pk_fma_f32 v[120:121], v[120:121], v[12:13], v[14:15] op_sel:[0,1,1] op_sel_hi:[1,1,1]
  v_pk_fma_f32 v[122:123], v[122:123], v[12:13], v[14:15] op_sel:[0,1,1] op_sel_hi:[1,1,1]
  v_pk_fma_f32 v[124:125], v[124:125], v[12:13], v[14:15] op_sel:[0,1,1] op_sel_hi:[1,1,1]
  v_pk_fma_f32 v[126:127], v[126:127], v[12:13], v[14:15] op_sel:[0,1,1] op_sel_hi:[1,1,1]
  v_cvt_pk_bf16_f32 v153, v112, v120
  v_cvt_pk_bf16_f32 v157, v113, v121
  v_cvt_pk_bf16_f32 v161, v114, v122
  v_cvt_pk_bf16_f32 v165, v115, v123
  v_cvt_pk_bf16_f32 v169, v116, v124
  v_cvt_pk_bf16_f32 v173, v117, v125
  v_cvt_pk_bf16_f32 v177, v118, v126
  v_cvt_pk_bf16_f32 v181, v119, v127
  s_waitcnt vmcnt(12)
  v_cvt_f32_i32 v96, v64
  v_cvt_f32_i32 v97, v65
  v_cvt_f32_i32 v98, v66
  v_cvt_f32_i32 v99, v67
  v_cvt_f32_i32 v100, v68
  v_cvt_f32_i32 v101, v69
  v_cvt_f32_i32 v102, v70
  v_cvt_f32_i32 v103, v71
  v_cvt_f32_i32 v104, v72
  v_cvt_f32_i32 v105, v73
  v_cvt_f32_i32 v106, v74
  v_cvt_f32_i32 v107, v75
  v_cvt_f32_i32 v108, v76
  v_cvt_f32_i32 v109, v77
  v_cvt_f32_i32 v110, v78
  v_cvt_f32_i32 v111, v79
  buffer_load_dwordx4 v[64:67], v2, s[28:31], s36 offen offset:0 nt
  buffer_load_dwordx4 v[68:71], v2, s[28:31], s36 offen offset:256 nt
  buffer_load_dwordx4 v[72:75], v2, s[28:31], s36 offen offset:512 nt
  buffer_load_dwordx4 v[76:79], v2, s[28:31], s36 offen offset:768 nt
  s_add_u32 s37, s37, 32768
  s_and_b32 s37, s37, 0x7ffff
  s_add_u32 s36, s69, s37
  s_waitcnt lgkmcnt(0)
  s_lshr_b32 s46, s67, 6
  s_add_u32 s46, s46, 3584
  s_and_b32 s46, s46, 0x1fff
  v_add_u32 v1, s46, v4
  ds_read_b128 v[12:15], v1 offset:8192
  v_pk_fma_f32 v[96:97], v[96:97], v[8:9], v[10:11] op_sel:[0,0,0] op_sel_hi:[1,0,0]
  v_pk_fma_f32 v[98:99], v[98:99], v[8:9], v[10:11] op_sel:[0,0,0] op_sel_hi:[1,0,0]
  v_pk_fma_f32 v[100:101], v[100:101], v[8:9], v[10:11] op_sel:[0,0,0] op_sel_hi:[1,0,0]
  v_pk_fma_f32 v[102:103], v[102:103], v[8:9], v[10:11] op_sel:[0,0,0] op_sel_hi:[1,0,0]
  v_pk_fma_f32 v[104:105], v[104:105], v[8:9], v[10:11] op_sel:[0,1,1] op_sel_hi:[1,1,1]
  v_pk_fma_f32 v[106:107], v[106:107], v[8:9], v[10:11] op_sel:[0,1,1] op_sel_hi:[1,1,1]
  v_pk_fma_f32 v[108:109], v[108:109], v[8:9], v[10:11] op_sel:[0,1,1] op_sel_hi:[1,1,1]
  v_pk_fma_f32 v[110:111], v[110:111], v[8:9], v[10:11] op_sel:[0,1,1] op_sel_hi:[1,1,1]
  v_cvt_pk_bf16_f32 v154, v96, v104
  v_cvt_pk_bf16_f32 v158, v97, v105
  v_cvt_pk_bf16_f32 v162, v98, v106
  v_cvt_pk_bf16_f32 v166, v99, v107
  v_cvt_pk_bf16_f32 v170, v100, v108
  v_cvt_pk_bf16_f32 v174, v101, v109
  v_cvt_pk_bf16_f32 v178, v102, v110
  v_cvt_pk_bf16_f32 v182, v103, v111
  s_waitcnt vmcnt(12)
  v_cvt_f32_i32 v112, v80
  v_cvt_f32_i32 v113, v81
  v_cvt_f32_i32 v114, v82
  v_cvt_f32_i32 v115, v83
  v_cvt_f32_i32 v116, v84
  v_cvt_f32_i32 v117, v85
  v_cvt_f32_i32 v118, v86
  v_cvt_f32_i32 v119, v87
  v_cvt_f32_i32 v120, v88
  v_cvt_f32_i32 v121, v89
  v_cvt_f32_i32 v122, v90
  v_cvt_f32_i32 v123, v91
  v_cvt_f32_i32 v124, v92
  v_cvt_f32_i32 v125, v93
  v_cvt_f32_i32 v126, v94
  v_cvt_f32_i32 v127, v95
  buffer_load_dwordx4 v[80:83], v2, s[28:31], s36 offen offset:0 nt
  buffer_load_dwordx4 v[84:87], v2, s[28:31], s36 offen offset:256 nt
  buffer_load_dwordx4 v[88:91], v2, s[28:31], s36 offen offset:512 nt
  buffer_load_dwordx4 v[92:95], v2, s[28:31], s36 offen offset:768 nt
  s_add_u32 s37, s37, 32768
  s_and_b32 s37, s37, 0x7ffff
  s_add_u32 s36, s69, s37
  s_waitcnt lgkmcnt(0)
  s_lshr_b32 s46, s67, 6
  s_add_u32 s46, s46, 4096
  s_and_b32 s46, s46, 0x1fff
  v_add_u32 v1, s46, v4
  ds_read_b128 v[8:11], v1 offset:8192
  v_pk_fma_f32 v[112:113], v[112:113], v[12:13], v[14:15] op_sel:[0,0,0] op_sel_hi:[1,0,0]
  v_pk_fma_f32 v[114:115], v[114:115], v[12:13], v[14:15] op_sel:[0,0,0] op_sel_hi:[1,0,0]
  v_pk_fma_f32 v[116:117], v[116:117], v[12:13], v[14:15] op_sel:[0,0,0] op_sel_hi:[1,0,0]
  v_pk_fma_f32 v[118:119], v[118:119], v[12:13], v[14:15] op_sel:[0,0,0] op_sel_hi:[1,0,0]
  v_pk_fma_f32 v[120:121], v[120:121], v[12:13], v[14:15] op_sel:[0,1,1] op_sel_hi:[1,1,1]
  v_pk_fma_f32 v[122:123], v[122:123], v[12:13], v[14:15] op_sel:[0,1,1] op_sel_hi:[1,1,1]
  v_pk_fma_f32 v[124:125], v[124:125], v[12:13], v[14:15] op_sel:[0,1,1] op_sel_hi:[1,1,1]
  v_pk_fma_f32 v[126:127], v[126:127], v[12:13], v[14:15] op_sel:[0,1,1] op_sel_hi:[1,1,1]
  v_cvt_pk_bf16_f32 v155, v112, v120
  v_cvt_pk_bf16_f32 v159, v113, v121
  v_cvt_pk_bf16_f32 v163, v114, v122
  v_cvt_pk_bf16_f32 v167, v115, v123
  v_cvt_pk_bf16_f32 v171, v116, v124
  v_cvt_pk_bf16_f32 v175, v117, v125
  v_cvt_pk_bf16_f32 v179, v118, v126
  v_cvt_pk_bf16_f32 v183, v119, v127
  v_mfma_f32_16x16x32_bf16 v[184:187], v[132:135], v[152:155], v[184:187]
  v_mfma_f32_16x16x32_bf16 v[188:191], v[132:135], v[156:159], v[188:191]
  v_mfma_f32_16x16x32_bf16 v[192:195], v[132:135], v[160:163], v[192:195]
  v_mfma_f32_16x16x32_bf16 v[196:199], v[132:135], v[164:167], v[196:199]
  v_mfma_f32_16x16x32_bf16 v[200:203], v[132:135], v[168:171], v[200:203]
  v_mfma_f32_16x16x32_bf16 v[204:207], v[132:135], v[172:175], v[204:207]
  v_mfma_f32_16x16x32_bf16 v[208:211], v[132:135], v[176:179], v[208:211]
  v_mfma_f32_16x16x32_bf16 v[212:215], v[132:135], v[180:183], v[212:215]
  s_waitcnt vmcnt(12)
  v_cvt_f32_i32 v96, v32
  v_cvt_f32_i32 v97, v33
  v_cvt_f32_i32 v98, v34
  v_cvt_f32_i32 v99, v35
  v_cvt_f32_i32 v100, v36
  v_cvt_f32_i32 v101, v37
  v_cvt_f32_i32 v102, v38
  v_cvt_f32_i32 v103, v39
  v_cvt_f32_i32 v104, v40
  v_cvt_f32_i32 v105, v41
  v_cvt_f32_i32 v106, v42
  v_cvt_f32_i32 v107, v43
  v_cvt_f32_i32 v108, v44
  v_cvt_f32_i32 v109, v45
  v_cvt_f32_i32 v110, v46
  v_cvt_f32_i32 v111, v47
  buffer_load_dwordx4 v[32:35], v2, s[28:31], s36 offen offset:0 nt
  buffer_load_dwordx4 v[36:39], v2, s[28:31], s36 offen offset:256 nt
  buffer_load_dwordx4 v[40:43], v2, s[28:31], s36 offen offset:512 nt
  buffer_load_dwordx4 v[44:47], v2, s[28:31], s36 offen offset:768 nt
  s_add_u32 s37, s37, 32768
  s_and_b32 s37, s37, 0x7ffff
  s_add_u32 s36, s69, s37
  s_waitcnt lgkmcnt(0)
  s_lshr_b32 s46, s67, 6
  s_add_u32 s46, s46, 4608
  s_and_b32 s46, s46, 0x1fff
  v_add_u32 v1, s46, v4
  ds_read_b128 v[12:15], v1 offset:8192
  v_pk_fma_f32 v[96:97], v[96:97], v[8:9], v[10:11] op_sel:[0,0,0] op_sel_hi:[1,0,0]
  v_pk_fma_f32 v[98:99], v[98:99], v[8:9], v[10:11] op_sel:[0,0,0] op_sel_hi:[1,0,0]
  v_pk_fma_f32 v[100:101], v[100:101], v[8:9], v[10:11] op_sel:[0,0,0] op_sel_hi:[1,0,0]
  v_pk_fma_f32 v[102:103], v[102:103], v[8:9], v[10:11] op_sel:[0,0,0] op_sel_hi:[1,0,0]
  v_pk_fma_f32 v[104:105], v[104:105], v[8:9], v[10:11] op_sel:[0,1,1] op_sel_hi:[1,1,1]
  v_pk_fma_f32 v[106:107], v[106:107], v[8:9], v[10:11] op_sel:[0,1,1] op_sel_hi:[1,1,1]
  v_pk_fma_f32 v[108:109], v[108:109], v[8:9], v[10:11] op_sel:[0,1,1] op_sel_hi:[1,1,1]
  v_pk_fma_f32 v[110:111], v[110:111], v[8:9], v[10:11] op_sel:[0,1,1] op_sel_hi:[1,1,1]
  v_cvt_pk_bf16_f32 v152, v96, v104
  v_cvt_pk_bf16_f32 v156, v97, v105
  v_cvt_pk_bf16_f32 v160, v98, v106
  v_cvt_pk_bf16_f32 v164, v99, v107
  v_cvt_pk_bf16_f32 v168, v100, v108
  v_cvt_pk_bf16_f32 v172, v101, v109
  v_cvt_pk_bf16_f32 v176, v102, v110
  v_cvt_pk_bf16_f32 v180, v103, v111
  s_waitcnt vmcnt(12)
  v_cvt_f32_i32 v112, v48
  v_cvt_f32_i32 v113, v49
  v_cvt_f32_i32 v114, v50
  v_cvt_f32_i32 v115, v51
  v_cvt_f32_i32 v116, v52
  v_cvt_f32_i32 v117, v53
  v_cvt_f32_i32 v118, v54
  v_cvt_f32_i32 v119, v55
  v_cvt_f32_i32 v120, v56
  v_cvt_f32_i32 v121, v57
  v_cvt_f32_i32 v122, v58
  v_cvt_f32_i32 v123, v59
  v_cvt_f32_i32 v124, v60
  v_cvt_f32_i32 v125, v61
  v_cvt_f32_i32 v126, v62
  v_cvt_f32_i32 v127, v63
  buffer_load_dwordx4 v[48:51], v2, s[28:31], s36 offen offset:0 nt
  buffer_load_dwordx4 v[52:55], v2, s[28:31], s36 offen offset:256 nt
  buffer_load_dwordx4 v[56:59], v2, s[28:31], s36 offen offset:512 nt
  buffer_load_dwordx4 v[60:63], v2, s[28:31], s36 offen offset:768 nt
  s_add_u32 s37, s37, 32768
  s_and_b32 s37, s37, 0x7ffff
  s_add_u32 s36, s69, s37
  s_waitcnt lgkmcnt(0)
  s_lshr_b32 s46, s67, 6
  s_add_u32 s46, s46, 5120
  s_and_b32 s46, s46, 0x1fff
  v_add_u32 v1, s46, v4
  ds_read_b128 v[8:11], v1 offset:8192
  v_pk_fma_f32 v[112:113], v[112:113], v[12:13], v[14:15] op_sel:[0,0,0] op_sel_hi:[1,0,0]
  v_pk_fma_f32 v[114:115], v[114:115], v[12:13], v[14:15] op_sel:[0,0,0] op_sel_hi:[1,0,0]
  v_pk_fma_f32 v[116:117], v[116:117], v[12:13], v[14:15] op_sel:[0,0,0] op_sel_hi:[1,0,0]
  v_pk_fma_f32 v[118:119], v[118:119], v[12:13], v[14:15] op_sel:[0,0,0] op_sel_hi:[1,0,0]
  v_pk_fma_f32 v[120:121], v[120:121], v[12:13], v[14:15] op_sel:[0,1,1] op_sel_hi:[1,1,1]
  v_pk_fma_f32 v[122:123], v[122:123], v[12:13], v[14:15] op_sel:[0,1,1] op_sel_hi:[1,1,1]
  v_pk_fma_f32 v[124:125], v[124:125], v[12:13], v[14:15] op_sel:[0,1,1] op_sel_hi:[1,1,1]
  v_pk_fma_f32 v[126:127], v[126:127], v[12:13], v[14:15] op_sel:[0,1,1] op_sel_hi:[1,1,1]
  v_cvt_pk_bf16_f32 v153, v112, v120
  v_cvt_pk_bf16_f32 v157, v113, v121
  v_cvt_pk_bf16_f32 v161, v114, v122
  v_cvt_pk_bf16_f32 v165, v115, v123
  v_cvt_pk_bf16_f32 v169, v116, v124
  v_cvt_pk_bf16_f32 v173, v117, v125
  v_cvt_pk_bf16_f32 v177, v118, v126
  v_cvt_pk_bf16_f32 v181, v119, v127
  s_mov_b64 exec, 1
  ds_add_u32 v3, v24 offset:8
  s_mov_b64 exec, -1
  s_waitcnt vmcnt(12)
  v_cvt_f32_i32 v96, v64
  v_cvt_f32_i32 v97, v65
  v_cvt_f32_i32 v98, v66
  v_cvt_f32_i32 v99, v67
  v_cvt_f32_i32 v100, v68
  v_cvt_f32_i32 v101, v69
  v_cvt_f32_i32 v102, v70
  v_cvt_f32_i32 v103, v71
  v_cvt_f32_i32 v104, v72
  v_cvt_f32_i32 v105, v73
  v_cvt_f32_i32 v106, v74
  v_cvt_f32_i32 v107, v75
  v_cvt_f32_i32 v108, v76
  v_cvt_f32_i32 v109, v77
  v_cvt_f32_i32 v110, v78
  v_cvt_f32_i32 v111, v79
  buffer_load_dwordx4 v[64:67], v2, s[28:31], s36 offen offset:0 nt
  buffer_load_dwordx4 v[68:71], v2, s[28:31], s36 offen offset:256 nt
  buffer_load_dwordx4 v[72:75], v2, s[28:31], s36 offen offset:512 nt
  buffer_load_dwordx4 v[76:79], v2, s[28:31], s36 offen offset:768 nt
  s_add_u32 s37, s37, 32768
  s_and_b32 s37, s37, 0x7ffff
  s_add_u32 s36, s69, s37
  s_waitcnt lgkmcnt(0)
  s_lshr_b32 s46, s67, 6
  s_add_u32 s46, s46, 5632
  s_and_b32 s46, s46, 0x1fff
  v_add_u32 v1, s46, v4
  ds_read_b128 v[12:15], v1 offset:8192
  v_pk_fma_f32 v[96:97], v[96:97], v[8:9], v[10:11] op_sel:[0,0,0] op_sel_hi:[1,0,0]
  v_pk_fma_f32 v[98:99], v[98:99], v[8:9], v[10:11] op_sel:[0,0,0] op_sel_hi:[1,0,0]
  v_pk_fma_f32 v[100:101], v[100:101], v[8:9], v[10:11] op_sel:[0,0,0] op_sel_hi:[1,0,0]
  v_pk_fma_f32 v[102:103], v[102:103], v[8:9], v[10:11] op_sel:[0,0,0] op_sel_hi:[1,0,0]
  v_pk_fma_f32 v[104:105], v[104:105], v[8:9], v[10:11] op_sel:[0,1,1] op_sel_hi:[1,1,1]
  v_pk_fma_f32 v[106:107], v[106:107], v[8:9], v[10:11] op_sel:[0,1,1] op_sel_hi:[1,1,1]
  v_pk_fma_f32 v[108:109], v[108:109], v[8:9], v[10:11] op_sel:[0,1,1] op_sel_hi:[1,1,1]
  v_pk_fma_f32 v[110:111], v[110:111], v[8:9], v[10:11] op_sel:[0,1,1] op_sel_hi:[1,1,1]
  v_cvt_pk_bf16_f32 v154, v96, v104
  v_cvt_pk_bf16_f32 v158, v97, v105
  v_cvt_pk_bf16_f32 v162, v98, v106
  v_cvt_pk_bf16_f32 v166, v99, v107
  v_cvt_pk_bf16_f32 v170, v100, v108
  v_cvt_pk_bf16_f32 v174, v101, v109
  v_cvt_pk_bf16_f32 v178, v102, v110
  v_cvt_pk_bf16_f32 v182, v103, v111
  s_waitcnt vmcnt(12)
  v_cvt_f32_i32 v112, v80
  v_cvt_f32_i32 v113, v81
  v_cvt_f32_i32 v114, v82
  v_cvt_f32_i32 v115, v83
  v_cvt_f32_i32 v116, v84
  v_cvt_f32_i32 v117, v85
  v_cvt_f32_i32 v118, v86
  v_cvt_f32_i32 v119, v87
  v_cvt_f32_i32 v120, v88
  v_cvt_f32_i32 v121, v89
  v_cvt_f32_i32 v122, v90
  v_cvt_f32_i32 v123, v91
  v_cvt_f32_i32 v124, v92
  v_cvt_f32_i32 v125, v93
  v_cvt_f32_i32 v126, v94
  v_cvt_f32_i32 v127, v95
  buffer_load_dwordx4 v[80:83], v2, s[28:31], s36 offen offset:0 nt
  buffer_load_dwordx4 v[84:87], v2, s[28:31], s36 offen offset:256 nt
  buffer_load_dwordx4 v[88:91], v2, s[28:31], s36 offen offset:512 nt
  buffer_load_dwordx4 v[92:95], v2, s[28:31], s36 offen offset:768 nt
  s_waitcnt lgkmcnt(0)
  s_lshr_b32 s46, s67, 6
  s_add_u32 s46, s46, 6144
  s_and_b32 s46, s46, 0x1fff
  v_add_u32 v1, s46, v4
  ds_read_b128 v[8:11], v1 offset:8192
  v_pk_fma_f32 v[112:113], v[112:113], v[12:13], v[14:15] op_sel:[0,0,0] op_sel_hi:[1,0,0]
  v_pk_fma_f32 v[114:115], v[114:115], v[12:13], v[14:15] op_sel:[0,0,0] op_sel_hi:[1,0,0]
  v_pk_fma_f32 v[116:117], v[116:117], v[12:13], v[14:15] op_sel:[0,0,0] op_sel_hi:[1,0,0]
  v_pk_fma_f32 v[118:119], v[118:119], v[12:13], v[14:15] op_sel:[0,0,0] op_sel_hi:[1,0,0]
  v_pk_fma_f32 v[120:121], v[120:121], v[12:13], v[14:15] op_sel:[0,1,1] op_sel_hi:[1,1,1]
  v_pk_fma_f32 v[122:123], v[122:123], v[12:13], v[14:15] op_sel:[0,1,1] op_sel_hi:[1,1,1]
  v_pk_fma_f32 v[124:125], v[124:125], v[12:13], v[14:15] op_sel:[0,1,1] op_sel_hi:[1,1,1]
  v_pk_fma_f32 v[126:127], v[126:127], v[12:13], v[14:15] op_sel:[0,1,1] op_sel_hi:[1,1,1]
  v_cvt_pk_bf16_f32 v155, v112, v120
  v_cvt_pk_bf16_f32 v159, v113, v121
  v_cvt_pk_bf16_f32 v163, v114, v122
  v_cvt_pk_bf16_f32 v167, v115, v123
  v_cvt_pk_bf16_f32 v171, v116, v124
  v_cvt_pk_bf16_f32 v175, v117, v125
  v_cvt_pk_bf16_f32 v179, v118, v126
  v_cvt_pk_bf16_f32 v183, v119, v127
  v_mfma_f32_16x16x32_bf16 v[184:187], v[136:139], v[152:155], v[184:187]
  v_mfma_f32_16x16x32_bf16 v[188:191], v[136:139], v[156:159], v[188:191]
  v_mfma_f32_16x16x32_bf16 v[192:195], v[136:139], v[160:163], v[192:195]
  v_mfma_f32_16x16x32_bf16 v[196:199], v[136:139], v[164:167], v[196:199]
  v_mfma_f32_16x16x32_bf16 v[200:203], v[136:139], v[168:171], v[200:203]
  v_mfma_f32_16x16x32_bf16 v[204:207], v[136:139], v[172:175], v[204:207]
  v_mfma_f32_16x16x32_bf16 v[208:211], v[136:139], v[176:179], v[208:211]
  v_mfma_f32_16x16x32_bf16 v[212:215], v[136:139], v[180:183], v[212:215]
  ds_read_b32 v28, v3 offset:16
  s_waitcnt lgkmcnt(0)
  v_readfirstlane_b32 s46, v28
  s_nop 3
  s_cmp_lg_u32 s46, 8
  s_cbranch_scc1 L_nofac
  ds_read_b128 v[216:219], v25 offset:51200
  ds_read_b128 v[220:223], v25 offset:51216
  ds_read_b128 v[224:227], v25 offset:51232
  ds_read_b128 v[228:231], v25 offset:51248
  s_waitcnt lgkmcnt(0)
  v_max3_f32 v242, v216, v218, v220
  v_max3_f32 v242, v242, v222, v224
  v_max3_f32 v242, v242, v226, v228
  v_max_f32 v242, v242, v230
  v_sub_f32 v232, v216, v242
  v_mul_f32 v232, s44, v232
  v_exp_f32 v232, v232
  v_sub_f32 v233, v218, v242
  v_mul_f32 v233, s44, v233
  v_exp_f32 v233, v233
  v_sub_f32 v234, v220, v242
  v_mul_f32 v234, s44, v234
  v_exp_f32 v234, v234
  v_sub_f32 v235, v222, v242
  v_mul_f32 v235, s44, v235
  v_exp_f32 v235, v235
  v_sub_f32 v236, v224, v242
  v_mul_f32 v236, s44, v236
  v_exp_f32 v236, v236
  v_sub_f32 v237, v226, v242
  v_mul_f32 v237, s44, v237
  v_exp_f32 v237, v237
  v_sub_f32 v238, v228, v242
  v_mul_f32 v238, s44, v238
  v_exp_f32 v238, v238
  v_sub_f32 v239, v230, v242
  v_mul_f32 v239, s44, v239
  v_exp_f32 v239, v239
  v_mul_f32 v243, v232, v217
  v_fmac_f32 v243, v233, v219
  v_fmac_f32 v243, v234, v221
  v_fmac_f32 v243, v235, v223
  v_fmac_f32 v243, v236, v225
  v_fmac_f32 v243, v237, v227
  v_fmac_f32 v243, v238, v229
  v_fmac_f32 v243, v239, v231
  s_mov_b32 s66, 1
L_nofac:
  s_waitcnt vmcnt(12)
  v_cvt_f32_i32 v96, v32
  v_cvt_f32_i32 v97, v33
  v_cvt_f32_i32 v98, v34
  v_cvt_f32_i32 v99, v35
  v_cvt_f32_i32 v100, v36
  v_cvt_f32_i32 v101, v37
  v_cvt_f32_i32 v102, v38
  v_cvt_f32_i32 v103, v39
  v_cvt_f32_i32 v104, v40
  v_cvt_f32_i32 v105, v41
  v_cvt_f32_i32 v106, v42
  v_cvt_f32_i32 v107, v43
  v_cvt_f32_i32 v108, v44
  v_cvt_f32_i32 v109, v45
  v_cvt_f32_i32 v110, v46
  v_cvt_f32_i32 v111, v47
  s_waitcnt lgkmcnt(0)
  s_lshr_b32 s46, s67, 6
  s_add_u32 s46, s46, 6656
  s_and_b32 s46, s46, 0x1fff
  v_add_u32 v1, s46, v4
  ds_read_b128 v[12:15], v1 offset:8192
  v_pk_fma_f32 v[96:97], v[96:97], v[8:9], v[10:11] op_sel:[0,0,0] op_sel_hi:[1,0,0]
  v_pk_fma_f32 v[98:99], v[98:99], v[8:9], v[10:11] op_sel:[0,0,0] op_sel_hi:[1,0,0]
  v_pk_fma_f32 v[100:101], v[100:101], v[8:9], v[10:11] op_sel:[0,0,0] op_sel_hi:[1,0,0]
  v_pk_fma_f32 v[102:103], v[102:103], v[8:9], v[10:11] op_sel:[0,0,0] op_sel_hi:[1,0,0]
  v_pk_fma_f32 v[104:105], v[104:105], v[8:9], v[10:11] op_sel:[0,1,1] op_sel_hi:[1,1,1]
  v_pk_fma_f32 v[106:107], v[106:107], v[8:9], v[10:11] op_sel:[0,1,1] op_sel_hi:[1,1,1]
  v_pk_fma_f32 v[108:109], v[108:109], v[8:9], v[10:11] op_sel:[0,1,1] op_sel_hi:[1,1,1]
  v_pk_fma_f32 v[110:111], v[110:111], v[8:9], v[10:11] op_sel:[0,1,1] op_sel_hi:[1,1,1]
  v_cvt_pk_bf16_f32 v152, v96, v104
  v_cvt_pk_bf16_f32 v156, v97, v105
  v_cvt_pk_bf16_f32 v160, v98, v106
  v_cvt_pk_bf16_f32 v164, v99, v107
  v_cvt_pk_bf16_f32 v168, v100, v108
  v_cvt_pk_bf16_f32 v172, v101, v109
  v_cvt_pk_bf16_f32 v176, v102, v110
  v_cvt_pk_bf16_f32 v180, v103, v111
  s_waitcnt vmcnt(8)
  v_cvt_f32_i32 v112, v48
  v_cvt_f32_i32 v113, v49
  v_cvt_f32_i32 v114, v50
  v_cvt_f32_i32 v115, v51
  v_cvt_f32_i32 v116, v52
  v_cvt_f32_i32 v117, v53
  v_cvt_f32_i32 v118, v54
  v_cvt_f32_i32 v119, v55
  v_cvt_f32_i32 v120, v56
  v_cvt_f32_i32 v121, v57
  v_cvt_f32_i32 v122, v58
  v_cvt_f32_i32 v123, v59
  v_cvt_f32_i32 v124, v60
  v_cvt_f32_i32 v125, v61
  v_cvt_f32_i32 v126, v62
  v_cvt_f32_i32 v127, v63
  s_waitcnt lgkmcnt(0)
  s_lshr_b32 s46, s67, 6
  s_add_u32 s46, s46, 7168
  s_and_b32 s46, s46, 0x1fff
  v_add_u32 v1, s46, v4
  ds_read_b128 v[8:11], v1 offset:8192
  v_pk_fma_f32 v[112:113], v[112:113], v[12:13], v[14:15] op_sel:[0,0,0] op_sel_hi:[1,0,0]
  v_pk_fma_f32 v[114:115], v[114:115], v[12:13], v[14:15] op_sel:[0,0,0] op_sel_hi:[1,0,0]
  v_pk_fma_f32 v[116:117], v[116:117], v[12:13], v[14:15] op_sel:[0,0,0] op_sel_hi:[1,0,0]
  v_pk_fma_f32 v[118:119], v[118:119], v[12:13], v[14:15] op_sel:[0,0,0] op_sel_hi:[1,0,0]
  v_pk_fma_f32 v[120:121], v[120:121], v[12:13], v[14:15] op_sel:[0,1,1] op_sel_hi:[1,1,1]
  v_pk_fma_f32 v[122:123], v[122:123], v[12:13], v[14:15] op_sel:[0,1,1] op_sel_hi:[1,1,1]
  v_pk_fma_f32 v[124:125], v[124:125], v[12:13], v[14:15] op_sel:[0,1,1] op_sel_hi:[1,1,1]
  v_pk_fma_f32 v[126:127], v[126:127], v[12:13], v[14:15] op_sel:[0,1,1] op_sel_hi:[1,1,1]
  v_cvt_pk_bf16_f32 v153, v112, v120
  v_cvt_pk_bf16_f32 v157, v113, v121
  v_cvt_pk_bf16_f32 v161, v114, v122
  v_cvt_pk_bf16_f32 v165, v115, v123
  v_cvt_pk_bf16_f32 v169, v116, v124
  v_cvt_pk_bf16_f32 v173, v117, v125
  v_cvt_pk_bf16_f32 v177, v118, v126
  v_cvt_pk_bf16_f32 v181, v119, v127
  s_waitcnt vmcnt(4)
  v_cvt_f32_i32 v96, v64
  v_cvt_f32_i32 v97, v65
  v_cvt_f32_i32 v98, v66
  v_cvt_f32_i32 v99, v67
  v_cvt_f32_i32 v100, v68
  v_cvt_f32_i32 v101, v69
  v_cvt_f32_i32 v102, v70
  v_cvt_f32_i32 v103, v71
  v_cvt_f32_i32 v104, v72
  v_cvt_f32_i32 v105, v73
  v_cvt_f32_i32 v106, v74
  v_cvt_f32_i32 v107, v75
  v_cvt_f32_i32 v108, v76
  v_cvt_f32_i32 v109, v77
  v_cvt_f32_i32 v110, v78
  v_cvt_f32_i32 v111, v79
  s_waitcnt lgkmcnt(0)
  s_lshr_b32 s46, s67, 6
  s_add_u32 s46, s46, 7680
  s_and_b32 s46, s46, 0x1fff
  v_add_u32 v1, s46, v4
  ds_read_b128 v[12:15], v1 offset:8192
  v_pk_fma_f32 v[96:97], v[96:97], v[8:9], v[10:11] op_sel:[0,0,0] op_sel_hi:[1,0,0]
  v_pk_fma_f32 v[98:99], v[98:99], v[8:9], v[10:11] op_sel:[0,0,0] op_sel_hi:[1,0,0]
  v_pk_fma_f32 v[100:101], v[100:101], v[8:9], v[10:11] op_sel:[0,0,0] op_sel_hi:[1,0,0]
  v_pk_fma_f32 v[102:103], v[102:103], v[8:9], v[10:11] op_sel:[0,0,0] op_sel_hi:[1,0,0]
  v_pk_fma_f32 v[104:105], v[104:105], v[8:9], v[10:11] op_sel:[0,1,1] op_sel_hi:[1,1,1]
  v_pk_fma_f32 v[106:107], v[106:107], v[8:9], v[10:11] op_sel:[0,1,1] op_sel_hi:[1,1,1]
  v_pk_fma_f32 v[108:109], v[108:109], v[8:9], v[10:11] op_sel:[0,1,1] op_sel_hi:[1,1,1]
  v_pk_fma_f32 v[110:111], v[110:111], v[8:9], v[10:11] op_sel:[0,1,1] op_sel_hi:[1,1,1]
  v_cvt_pk_bf16_f32 v154, v96, v104
  v_cvt_pk_bf16_f32 v158, v97, v105
  v_cvt_pk_bf16_f32 v162, v98, v106
  v_cvt_pk_bf16_f32 v166, v99, v107
  v_cvt_pk_bf16_f32 v170, v100, v108
  v_cvt_pk_bf16_f32 v174, v101, v109
  v_cvt_pk_bf16_f32 v178, v102, v110
  v_cvt_pk_bf16_f32 v182, v103, v111
  s_waitcnt vmcnt(0)
  v_cvt_f32_i32 v112, v80
  v_cvt_f32_i32 v113, v81
  v_cvt_f32_i32 v114, v82
  v_cvt_f32_i32 v115, v83
  v_cvt_f32_i32 v116, v84
  v_cvt_f32_i32 v117, v85
  v_cvt_f32_i32 v118, v86
  v_cvt_f32_i32 v119, v87
  v_cvt_f32_i32 v120, v88
  v_cvt_f32_i32 v121, v89
  v_cvt_f32_i32 v122, v90
  v_cvt_f32_i32 v123, v91
  v_cvt_f32_i32 v124, v92
  v_cvt_f32_i32 v125, v93
  v_cvt_f32_i32 v126, v94
  v_cvt_f32_i32 v127, v95
  s_waitcnt lgkmcnt(0)
  v_pk_fma_f32 v[112:113], v[112:113], v[12:13], v[14:15] op_sel:[0,0,0] op_sel_hi:[1,0,0]
  v_pk_fma_f32 v[114:115], v[114:115], v[12:13], v[14:15] op_sel:[0,0,0] op_sel_hi:[1,0,0]
  v_pk_fma_f32 v[116:117], v[116:117], v[12:13], v[14:15] op_sel:[0,0,0] op_sel_hi:[1,0,0]
  v_pk_fma_f32 v[118:119], v[118:119], v[12:13], v[14:15] op_sel:[0,0,0] op_sel_hi:[1,0,0]
  v_pk_fma_f32 v[120:121], v[120:121], v[12:13], v[14:15] op_sel:[0,1,1] op_sel_hi:[1,1,1]
  v_pk_fma_f32 v[122:123], v[122:123], v[12:13], v[14:15] op_sel:[0,1,1] op_sel_hi:[1,1,1]
  v_pk_fma_f32 v[124:125], v[124:125], v[12:13], v[14:15] op_sel:[0,1,1] op_sel_hi:[1,1,1]
  v_pk_fma_f32 v[126:127], v[126:127], v[12:13], v[14:15] op_sel:[0,1,1] op_sel_hi:[1,1,1]
  v_cvt_pk_bf16_f32 v155, v112, v120
  v_cvt_pk_bf16_f32 v159, v113, v121
  v_cvt_pk_bf16_f32 v163, v114, v122
  v_cvt_pk_bf16_f32 v167, v115, v123
  v_cvt_pk_bf16_f32 v171, v116, v124
  v_cvt_pk_bf16_f32 v175, v117, v125
  v_cvt_pk_bf16_f32 v179, v118, v126
  v_cvt_pk_bf16_f32 v183, v119, v127
  v_mfma_f32_16x16x32_bf16 v[184:187], v[140:143], v[152:155], v[184:187]
  v_mfma_f32_16x16x32_bf16 v[188:191], v[140:143], v[156:159], v[188:191]
  v_mfma_f32_16x16x32_bf16 v[192:195], v[140:143], v[160:163], v[192:195]
  v_mfma_f32_16x16x32_bf16 v[196:199], v[140:143], v[164:167], v[196:199]
  v_mfma_f32_16x16x32_bf16 v[200:203], v[140:143], v[168:171], v[200:203]
  v_mfma_f32_16x16x32_bf16 v[204:207], v[140:143], v[172:175], v[204:207]
  v_mfma_f32_16x16x32_bf16 v[208:211], v[140:143], v[176:179], v[208:211]
  v_mfma_f32_16x16x32_bf16 v[212:215], v[140:143], v[180:183], v[212:215]
  s_nop 4
  v_cndmask_b32 v96, v184, v200, s[42:43]
  v_cndmask_b32 v97, v188, v204, s[42:43]
  v_cndmask_b32 v98, v192, v208, s[42:43]
  v_cndmask_b32 v99, v196, v212, s[42:43]
  ds_write_b128 v5, v[96:99] offset:18432
  v_cndmask_b32 v100, v185, v201, s[42:43]
  v_cndmask_b32 v101, v189, v205, s[42:43]
  v_cndmask_b32 v102, v193, v209, s[42:43]
  v_cndmask_b32 v103, v197, v213, s[42:43]
  ds_write_b128 v5, v[100:103] offset:18944
  v_cndmask_b32 v104, v186, v202, s[42:43]
  v_cndmask_b32 v105, v190, v206, s[42:43]
  v_cndmask_b32 v106, v194, v210, s[42:43]
  v_cndmask_b32 v107, v198, v214, s[42:43]
  ds_write_b128 v5, v[104:107] offset:19456
  v_cndmask_b32 v108, v187, v203, s[42:43]
  v_cndmask_b32 v109, v191, v207, s[42:43]
  v_cndmask_b32 v110, v195, v211, s[42:43]
  v_cndmask_b32 v111, v199, v215, s[42:43]
  ds_write_b128 v5, v[108:111] offset:19968
  s_mov_b64 exec, 1
  ds_add_u32 v3, v24 offset:4
  s_mov_b64 exec, -1
  s_cmp_lg_u32 s66, 0
  s_cbranch_scc1 L_facok
L_spin:
  ds_read_b32 v28, v3 offset:16
  s_waitcnt lgkmcnt(0)
  v_readfirstlane_b32 s46, v28
  s_nop 3
  s_cmp_eq_u32 s46, 8
  s_cbranch_scc1 L_dofac
  s_sleep 8
  s_branch L_spin
L_dofac:
  ds_read_b128 v[216:219], v25 offset:51200
  ds_read_b128 v[220:223], v25 offset:51216
  ds_read_b128 v[224:227], v25 offset:51232
  ds_read_b128 v[228:231], v25 offset:51248
  s_waitcnt lgkmcnt(0)
  v_max3_f32 v242, v216, v218, v220
  v_max3_f32 v242, v242, v222, v224
  v_max3_f32 v242, v242, v226, v228
  v_max_f32 v242, v242, v230
  v_sub_f32 v232, v216, v242
  v_mul_f32 v232, s44, v232
  v_exp_f32 v232, v232
  v_sub_f32 v233, v218, v242
  v_mul_f32 v233, s44, v233
  v_exp_f32 v233, v233
  v_sub_f32 v234, v220, v242
  v_mul_f32 v234, s44, v234
  v_exp_f32 v234, v234
  v_sub_f32 v235, v222, v242
  v_mul_f32 v235, s44, v235
  v_exp_f32 v235, v235
  v_sub_f32 v236, v224, v242
  v_mul_f32 v236, s44, v236
  v_exp_f32 v236, v236
  v_sub_f32 v237, v226, v242
  v_mul_f32 v237, s44, v237
  v_exp_f32 v237, v237
  v_sub_f32 v238, v228, v242
  v_mul_f32 v238, s44, v238
  v_exp_f32 v238, v238
  v_sub_f32 v239, v230, v242
  v_mul_f32 v239, s44, v239
  v_exp_f32 v239, v239
  v_mul_f32 v243, v232, v217
  v_fmac_f32 v243, v233, v219
  v_fmac_f32 v243, v234, v221
  v_fmac_f32 v243, v235, v223
  v_fmac_f32 v243, v236, v225
  v_fmac_f32 v243, v237, v227
  v_fmac_f32 v243, v238, v229
  v_fmac_f32 v243, v239, v231
  s_mov_b32 s66, 1
L_facok:
  s_cmp_lg_u32 s3, 0
  s_cbranch_scc1 L_bar2
  v_mov_b32 v27, s68
L_poll:
  ds_read_b64 v[28:29], v3 offset:4
  s_waitcnt lgkmcnt(0)
  v_readfirstlane_b32 s46, v28
  v_readfirstlane_b32 s39, v29
  s_nop 3
  s_cmp_eq_u32 s46, 8
  s_cbranch_scc1 L_bar2
  s_cmp_eq_u32 s39, 8
  s_cbranch_scc1 L_gpoll
  s_sleep 8
  s_branch L_poll
L_gpoll:
  global_load_dword v28, v27, s[22:23] sc0 sc1
  s_waitcnt vmcnt(0)
  v_readfirstlane_b32 s46, v28
  s_nop 3
  s_cmp_lg_u32 s46, 0
  s_cbranch_scc1 L_fetch
  s_sleep 1
  s_branch L_poll
L_fetch:
  s_xor_b32 s38, s64, 8192
  s_add_u32 s46, s38, 4096
  buffer_load_dwordx4 v[32:35], v30, s[32:35], s38 offen offset:0 sc0 sc1
  buffer_load_dwordx4 v[36:39], v30, s[32:35], s38 offen offset:1024 sc0 sc1
  buffer_load_dwordx4 v[40:43], v30, s[32:35], s38 offen offset:2048 sc0 sc1
  buffer_load_dwordx4 v[44:47], v30, s[32:35], s38 offen offset:3072 sc0 sc1
  buffer_load_dwordx4 v[48:51], v30, s[32:35], s46 offen offset:0 sc0 sc1
  buffer_load_dwordx4 v[52:55], v30, s[32:35], s46 offen offset:1024 sc0 sc1
  buffer_load_dwordx4 v[56:59], v30, s[32:35], s46 offen offset:2048 sc0 sc1
  buffer_load_dwordx4 v[60:63], v30, s[32:35], s46 offen offset:3072 sc0 sc1
  s_waitcnt vmcnt(7)
  ds_write_b128 v30, v[32:35] offset:51776
  s_waitcnt vmcnt(6)
  ds_write_b128 v30, v[36:39] offset:52800
  s_waitcnt vmcnt(5)
  ds_write_b128 v30, v[40:43] offset:53824
  s_waitcnt vmcnt(4)
  ds_write_b128 v30, v[44:47] offset:54848
  s_waitcnt vmcnt(3)
  ds_write_b128 v30, v[48:51] offset:55872
  s_waitcnt vmcnt(2)
  ds_write_b128 v30, v[52:55] offset:56896
  s_waitcnt vmcnt(1)
  ds_write_b128 v30, v[56:59] offset:57920
  s_waitcnt vmcnt(0)
  ds_write_b128 v30, v[60:63] offset:58944
  ds_write_b32 v3, v24 offset:12
L_bar2:
  s_waitcnt lgkmcnt(0)
  s_barrier
  ds_read_b64 v[32:33], v6 offset:18432
  ds_read_b64 v[34:35], v6 offset:22528
  ds_read_b64 v[36:37], v6 offset:26624
  ds_read_b64 v[38:39], v6 offset:30720
  ds_read_b64 v[40:41], v6 offset:34816
  ds_read_b64 v[42:43], v6 offset:38912
  ds_read_b64 v[44:45], v6 offset:43008
  ds_read_b64 v[46:47], v6 offset:47104
  ds_read_b32 v29, v3 offset:12
  ds_read_b128 v[244:247], v7 offset:51776
  s_waitcnt lgkmcnt(8)
  v_mul_f32 v240, v232, v32
  v_mul_f32 v241, v232, v33
  v_fmac_f32 v240, v233, v34
  v_fmac_f32 v241, v233, v35
  s_waitcnt lgkmcnt(2)
  v_fmac_f32 v240, v234, v36
  v_fmac_f32 v241, v234, v37
  v_fmac_f32 v240, v235, v38
  v_fmac_f32 v241, v235, v39
  v_fmac_f32 v240, v236, v40
  v_fmac_f32 v241, v236, v41
  v_fmac_f32 v240, v237, v42
  v_fmac_f32 v241, v237, v43
  v_fmac_f32 v240, v238, v44
  v_fmac_f32 v241, v238, v45
  v_fmac_f32 v240, v239, v46
  v_fmac_f32 v241, v239, v47
  s_waitcnt lgkmcnt(0)
  v_readfirstlane_b32 s46, v29
  s_nop 3
  s_cmp_lg_u32 s46, 0
  s_cbranch_scc1 L_final
  buffer_store_dwordx4 v[240:243], v30, s[32:35], s64 offen sc0 sc1
  v_mov_b32 v27, s68
  s_cmp_lg_u32 s3, 0
  s_cbranch_scc1 L_w1
  global_load_dword v29, v27, s[22:23] sc0 sc1
L_w1:
  s_waitcnt vmcnt(0)
  s_barrier
  s_cmp_lg_u32 s3, 0
  s_cbranch_scc1 L_wait
  v_readfirstlane_b32 s46, v29
  s_nop 3
  s_cmp_lg_u32 s46, 0
  s_cbranch_scc1 L_have
  s_lshl_b32 s39, 1, s47
  v_mov_b32 v28, s39
  v_mov_b32 v25, s70
  v_xor_b32 v27, 256, v27
  s_mov_b64 exec, 1
  global_store_dword v27, v24, s[22:23] sc0 sc1
  global_atomic_add v29, v25, v28, s[20:21] sc0 sc1
  s_mov_b64 exec, -1
  s_waitcnt vmcnt(0)
  v_lshrrev_b32 v29, s47, v29
  v_and_b32 v29, 0xffff, v29
L_have:
  s_mov_b64 exec, 1
  ds_write_b32 v3, v29
  s_mov_b64 exec, -1
  s_waitcnt lgkmcnt(0)
L_wait:
  s_barrier
  ds_read_b32 v29, v3
  s_waitcnt lgkmcnt(0)
  v_readfirstlane_b32 s46, v29
  s_nop 3
  s_cmp_eq_u32 s46, 0
  s_cbranch_scc1 L_fin
  s_xor_b32 s38, s64, 8192
  buffer_load_dwordx4 v[244:247], v30, s[32:35], s38 offen sc0 sc1
  s_waitcnt vmcnt(0)
L_final:
  v_max_f32 v27, v242, v246
  v_sub_f32 v242, v242, v27
  v_sub_f32 v246, v246, v27
  v_mul_f32 v242, s44, v242
  v_mul_f32 v246, s44, v246
  v_exp_f32 v242, v242
  v_exp_f32 v246, v246
  v_mul_f32 v243, v243, v242
  v_mul_f32 v247, v247, v246
  v_add_f32 v243, v243, v247
  v_rcp_f32 v243, v243
  v_mul_f32 v240, v240, v242
  v_mul_f32 v241, v241, v242
  v_mul_f32 v244, v244, v246
  v_mul_f32 v245, v245, v246
  v_add_f32 v240, v240, v244
  v_add_f32 v241, v241, v245
  v_mul_f32 v240, v240, v243
  v_mul_f32 v241, v241, v243
  v_cvt_pk_bf16_f32 v240, v240, v241
  buffer_store_dword v240, v31, s[56:59], s65 offen sc0 sc1
L_fin:
L_end:
  s_endpgm
.section .rodata,"a"
.p2align 6
.amdhsa_kernel standalone__kv_cache_quant_int4_int2_kv_with_per_channel_or_per_token_scales__sampling_kernel
  .amdhsa_next_free_vgpr 248
  .amdhsa_next_free_sgpr 80
  .amdhsa_accum_offset 248
  .amdhsa_group_segment_fixed_size 0
  .amdhsa_kernarg_size 80
  .amdhsa_user_sgpr_count 2
  .amdhsa_user_sgpr_kernarg_segment_ptr 1
  .amdhsa_system_sgpr_workgroup_id_x 1
.end_amdhsa_kernel
```
